```python
import torch

def _softmax(x, axis=-1):
    return torch.softmax(x, dim=axis)
def _gelu(x):
    return torch.nn.functional.gelu(x, approximate="tanh")
def _silu(x):
    return torch.nn.functional.silu(x)
def _sigmoid(x):
    return torch.sigmoid(x)
def _layernorm(x, axis=-1, eps=1e-5):
    m = x.mean(dim=axis, keepdim=True)
    v = x.var(dim=axis, keepdim=True, unbiased=False)
    return (x - m) / torch.sqrt(v + eps)
def _scatter_add(tgt, idx, src, axis=0):
    return tgt.clone().index_add_(axis, idx, src)
def _segment_sum(src, seg, n):
    out = torch.zeros((n,) + src.shape[1:], dtype=src.dtype)
    return out.index_add_(0, seg, src)
def _pad(x, pw):
    flat = tuple(v for pair in reversed(pw) for v in pair)
    return torch.nn.functional.pad(x, flat)

kernel_name = 'gather_scatter__kernel_systems_refs_featgraph__graph'

def setup_inputs():

    _w = (lambda a: (lambda t: t.to(torch.bfloat16) if t.is_floating_point() else t)(torch.as_tensor(a)))
    N, deg, D = 10000, 32, 128
    E = N * deg
    scale = D ** -0.5
    src = (lambda lo, hi, *s: torch.randint(lo, hi, s))(0, N, E).to(torch.int64)
    dst = (lambda lo, hi, *s: torch.randint(lo, hi, s))(0, N, E).to(torch.int64)
    return {
        "x": _w((lambda *s: torch.randn(*s, dtype=torch.bfloat16) * 0.8)(N, D)),
        "src": _w(src),
        "dst": _w(dst),
        "w_q": _w((lambda *s: torch.randn(*s, dtype=torch.bfloat16) * 0.8)(D, D) * scale),
        "w_v": _w((lambda *s: torch.randn(*s, dtype=torch.bfloat16) * 0.05)(D, D) * scale),
    }

def reference(x, src, dst, w_q, w_v):
    N, D = x.shape
    xs = x[src]
    xd = x[dst]
    q = xd @ w_q
    logits = torch.einsum('ed,ed->e', xs, q) * (float(D) ** -0.5)
    alpha = _sigmoid(logits)
    msg = alpha[:, None] * (xs @ w_v)
    return _segment_sum(msg, dst, N)
```

```asm
; @launch grid=(250,1,1) block=(1024,1,1) lds=163840
.amdgcn_target "amdgcn-amd-amdhsa--gfx950"
.text
.globl gather_scatter__kernel_systems_refs_featgraph__graph_kernel
.p2align 8
.type gather_scatter__kernel_systems_refs_featgraph__graph_kernel,@function
gather_scatter__kernel_systems_refs_featgraph__graph_kernel:
    s_cmp_ge_u32 s2, 250
    s_cbranch_scc1 L_end

    s_load_dwordx16 s[4:19], s[0:1], 0

    v_lshrrev_b32 v8, 6, v0
    v_and_b32 v1, 63, v0
    v_lshlrev_b32 v119, 4, v0
    v_readfirstlane_b32 s48, v8

    s_getpc_b64 s[62:63]
    s_and_b32 s62, s62, 0xffffff00
    v_lshlrev_b32 v35, 7, v1
    s_cmp_lg_u32 s48, 11
    s_cbranch_scc1 L_nocpf
    s_cmp_ge_u32 s2, 250
    s_cbranch_scc1 L_nocpf
    global_load_dword v36, v35, s[62:63]
    v_add_u32 v38, 0x2000, v35
    s_mov_b64 exec, 0xff
    global_load_dword v37, v38, s[62:63]
    s_mov_b64 exec, -1

    L_nocpf:

    s_and_b32 s64, s2, 0xfffffff0
    s_and_b32 s65, s2, 7
    s_lshl_b32 s65, s65, 1
    s_or_b32 s64, s64, s65
    s_bfe_u32 s65, s2, 0x10003
    s_or_b32 s64, s64, s65
    s_cmp_ge_u32 s2, 240
    s_cselect_b32 s54, s2, s64

    s_cmp_lt_u32 s48, 11
    s_cselect_b32 s66, 0x1fffff, -1
    s_mov_b32 s65, 96768
    s_cselect_b32 s65, 6144, s65
    s_mov_b32 s67, s66
    v_mov_b64 v[12:13], s[66:67]
    v_mov_b64 v[14:15], s[66:67]
    v_add_u32 v9, s65, v119
    ds_write_b128 v9, v[12:15]
    s_cmp_ge_u32 s48, 7
    s_cbranch_scc1 L_init2_done
    s_cmp_eq_u32 s48, 6
    s_cselect_b32 s66, 0, -1
    s_mov_b32 s65, 113152
    s_cselect_b32 s65, 0xffffe800, s65
    s_mov_b32 s67, s66
    v_mov_b64 v[16:17], s[66:67]
    v_mov_b64 v[18:19], s[66:67]
    v_add_u32 v9, s65, v119
    ds_write_b128 v9, v[16:19]

    L_init2_done:

    v_mov_b32 v2, 1
    v_mov_b32 v3, 4
    v_lshlrev_b32 v10, 4, v1
    s_mov_b32 s51, 0xbe0293ee
    s_mov_b32 s52, 0xaaaaaaaa
    s_mov_b32 s53, 0xaaaaaaaa
    s_mov_b32 s55, 30000
    s_mov_b32 s56, 0
    s_cmp_ge_u32 s48, 10
    s_cbranch_scc1 L_pre_dma
    v_lshlrev_b32 v9, 3, v0
    v_mov_b64 v[24:25], 0
    s_mul_i32 s64, s2, 5120
    s_waitcnt lgkmcnt(0)

    s_mov_b32 s28, s8
    s_mov_b32 s29, s9
    s_mov_b32 s30, 1280000
    s_mov_b32 s31, 0x20000
    s_mov_b32 s24, s6
    buffer_load_dwordx2 v[20:21], v9, s[28:31], s64 offen
    s_mov_b32 s25, s7
    s_mov_b32 s26, 1280000
    s_mov_b32 s27, 0x20000
    buffer_load_dwordx2 v[22:23], v9, s[24:27], s64 offen
    s_cmp_lg_u32 s48, 0
    s_cbranch_scc1 L_noep
    s_load_dword s59, s[18:19], 0
    L_noep:

    s_mov_b32 s20, s4
    s_mov_b32 s21, s5
    s_mov_b32 s22, 2560000
    s_mov_b32 s23, 0x20000
    s_mov_b32 s32, s10
    s_mov_b32 s33, s11
    s_mov_b32 s34, 32768
    s_mov_b32 s35, 0x20000
    s_mov_b32 s36, s12
    s_mov_b32 s37, s13
    s_mov_b32 s38, 32768
    s_mov_b32 s39, 0x20000
    s_branch L_pre_join
L_pre_dma:
    v_lshrrev_b32 v9, 4, v1
    v_and_b32 v8, 15, v1
    s_cmp_ge_u32 s48, 12
    s_cselect_b32 s64, 2, 0
    v_lshlrev_b32 v11, s64, v9
    v_xor_b32 v11, v8, v11
    v_lshlrev_b32 v11, 4, v11
    v_lshl_add_u32 v24, v9, 8, v11

    s_cbranch_scc0 L_tab_done
    s_cmp_eq_u32 s48, 13
    s_cbranch_scc1 L_tabB
    s_cmp_eq_u32 s48, 12
    s_cbranch_scc1 L_tabA
    s_cmp_eq_u32 s48, 14
    s_cselect_b32 s65, 2, 1
    s_cselect_b32 s66, 3, 1
    s_cselect_b32 s67, 0, 8
    v_lshrrev_b32 v12, 3, v1
    v_and_b32 v13, s66, v12
    v_lshrrev_b32 v12, s65, v12
    v_mul_u32_u24 v13, 0, v13
    v_and_b32 v14, 7, v1
    v_lshl_add_u32 v16, v14, 4, v13
    v_lshl_add_u32 v17, v12, 2, v13
    v_add_u32 v17, 108032, v17
    v_lshrrev_b32 v14, 5, v1
    v_lshl_add_u32 v18, v14, 7, v16
    v_lshrrev_b32 v14, 1, v1
    v_and_b32 v14, s67, v14
    v_add_u32 v18, v14, v18
    v_mov_b32 v19, v24
    s_sub_u32 s64, s48, 14
    s_lshl_b32 s64, s64, 10
    v_add_u32 v12, s64, v10
    ds_write_b128 v12, v[16:19] offset:4096
    s_branch L_tab_done
    L_tabA:
    v_and_b32 v12, 7, v1
    v_lshlrev_b32 v16, 4, v12
    v_lshlrev_b32 v12, 4, v1
    v_and_b32 v12, 16, v12
    s_mov_b32 s64, 0xffff
    s_mov_b32 s66, 0x33333333
    s_mov_b32 s67, 0x33333333
    v_lshlrev_b32 v12, v12, s64
    v_cndmask_b32 v18, v12, 0, s[66:67]
    v_xor_b32 v17, v12, v18
    v_mul_u32_u24 v19, 272, v1
    v_cmp_gt_u32 vcc, 40, v1
    v_add_u32 v19, 108032, v19
    v_mov_b32 v12, 0
    v_cndmask_b32 v19, v12, v19, vcc
    v_lshlrev_b32 v12, 2, v1
    ds_write_b128 v10, v[16:19] offset:2048
    ds_write_b32 v12, v19 offset:1024
    s_branch L_tab_done
    L_tabB:
    v_lshrrev_b32 v12, 2, v8
    v_lshl_add_u32 v13, v9, 3, v12
    v_lshlrev_b32 v13, 8, v13
    v_lshl_add_u32 v13, v12, 6, v13
    v_and_b32 v12, 1, v9
    v_lshl_add_u32 v13, v12, 5, v13
    v_and_b32 v12, 3, v8
    v_lshl_add_u32 v13, v12, 3, v13
    v_add_u32 v16, 42496, v13
    v_xor_b32 v12, v9, v8
    v_lshlrev_b32 v12, 4, v12
    v_lshl_add_u32 v12, v8, 8, v12
    v_add_u32 v17, 30208, v12
    v_lshlrev_b32 v12, 4, v9
    v_mul_u32_u24 v13, 272, v8
    v_add_u32 v18, v13, v12
    v_lshl_add_u32 v19, v8, 8, v12
    ds_write_b128 v10, v[16:19] offset:3072
    L_tab_done:

    s_sub_u32 s66, s48, 12
    s_and_b32 s65, s66, 2
    s_lshl_b32 s65, s65, 4
    s_sub_u32 s67, s48, 10
    s_lshl_b32 s64, s67, 6
    s_cmp_ge_u32 s48, 12
    s_cselect_b32 s65, s65, s64
    v_xor_b32 v24, s65, v24
    v_xor_b32 v25, 0x80, v24

    s_waitcnt lgkmcnt(0)

    s_mov_b32 s20, s4
    s_mov_b32 s21, s5
    s_mov_b32 s22, 2560000
    s_mov_b32 s23, 0x20000
    s_mov_b32 s32, s10
    s_mov_b32 s33, s11
    s_mov_b32 s34, 32768
    s_mov_b32 s35, 0x20000
    s_mov_b32 s36, s12
    s_mov_b32 s37, s13
    s_mov_b32 s38, 32768
    s_mov_b32 s39, 0x20000
    s_mov_b32 s24, s6
    s_mov_b32 s25, s7
    s_mov_b32 s26, 1280000
    s_mov_b32 s27, 0x20000
    s_mov_b32 s28, s8
    s_mov_b32 s29, s9
    s_mov_b32 s30, 1280000
    s_mov_b32 s31, 0x20000
L_pre_join:
    s_mov_b32 s40, s14
    s_mov_b32 s41, s15
    s_mov_b32 s42, 2560000
    s_mov_b32 s43, 0x20000
    s_mov_b32 s44, s18
    s_mov_b32 s45, s19
    s_mov_b32 s46, 134217728
    s_mov_b32 s47, 0x20000
    s_barrier
    s_cmp_lt_u32 s48, 10
    s_cbranch_scc1 L_dma_done
    s_sub_u32 s66, s48, 12
    s_cmp_ge_u32 s48, 12
    s_cbranch_scc1 L_dma_w

    s_sub_u32 s67, s48, 10
    s_lshl_b32 s64, s67, 10
    s_add_u32 m0, s64, 30208
    s_mul_i32 s65, s54, 10240
    s_add_u32 s64, s64, s65

    buffer_load_dwordx4 v24, s[20:23], s64 offen lds
    s_add_u32 m0, m0, 2048
    s_add_u32 s64, s64, 2048
    buffer_load_dwordx4 v25, s[20:23], s64 offen lds
    s_add_u32 m0, m0, 2048
    s_add_u32 s64, s64, 2048
    buffer_load_dwordx4 v24, s[20:23], s64 offen lds
    s_add_u32 m0, m0, 2048
    s_add_u32 s64, s64, 2048
    buffer_load_dwordx4 v25, s[20:23], s64 offen lds
    s_add_u32 m0, m0, 2048
    s_add_u32 s64, s64, 2048
    buffer_load_dwordx4 v24, s[20:23], s64 offen lds
    s_branch L_dma_done
L_dma_w:
    s_lshr_b32 s64, s2, 3
    s_lshl_b32 s64, s64, 12
    s_lshl_b32 s65, s66, 10
    s_add_u32 s64, s64, s65
    s_and_b32 s64, s64, 0x7fff

    s_add_u32 m0, s64, 42496
    s_add_u32 s65, s64, 4096
    buffer_load_dwordx4 v24, s[32:35], s64 offen lds
    s_and_b32 s64, s65, 0x7fff
    s_add_u32 m0, s64, 42496
    s_add_u32 s65, s64, 4096
    buffer_load_dwordx4 v24, s[32:35], s64 offen lds
    s_and_b32 s64, s65, 0x7fff
    s_add_u32 m0, s64, 42496
    s_add_u32 s65, s64, 4096
    buffer_load_dwordx4 v24, s[32:35], s64 offen lds
    s_and_b32 s64, s65, 0x7fff
    s_add_u32 m0, s64, 42496
    s_add_u32 s65, s64, 4096
    buffer_load_dwordx4 v24, s[32:35], s64 offen lds
    s_and_b32 s64, s65, 0x7fff
    s_add_u32 m0, s64, 42496
    s_add_u32 s65, s64, 4096
    buffer_load_dwordx4 v24, s[32:35], s64 offen lds
    s_and_b32 s64, s65, 0x7fff
    s_add_u32 m0, s64, 42496
    s_add_u32 s65, s64, 4096
    buffer_load_dwordx4 v24, s[32:35], s64 offen lds
    s_and_b32 s64, s65, 0x7fff
    s_add_u32 m0, s64, 42496
    s_add_u32 s65, s64, 4096
    buffer_load_dwordx4 v24, s[32:35], s64 offen lds
    s_and_b32 s64, s65, 0x7fff
    s_add_u32 m0, s64, 42496
    s_nop 0
    buffer_load_dwordx4 v24, s[32:35], s64 offen lds
L_dma_done:
    ds_read_b128 v[4:7], v10 offset:2048
    ds_read_b128 v[120:123], v10 offset:3072
    s_cmp_lt_u32 s48, 4
    s_cbranch_scc1 L_tc_long
    ds_read_b128 v[124:127], v10 offset:5120
    s_branch L_tc_done
    L_tc_long:
    ds_read_b128 v[124:127], v10 offset:4096
    L_tc_done:

    v_mov_b64 v[40:41], 0
    v_mov_b64 v[42:43], 0
    v_mov_b64 v[44:45], 0
    v_mov_b64 v[46:47], 0
    v_mov_b64 v[48:49], 0
    v_mov_b64 v[50:51], 0
    v_mov_b64 v[52:53], 0
    v_mov_b64 v[54:55], 0
    s_cmp_lt_u32 s48, 4
    s_cselect_b32 s76, 2, 1
    s_cselect_b32 s65, 0, 8
    s_lshl_b32 s64, s48, s76
    s_add_u32 s77, s64, s65
    s_cmp_eq_u32 s48, 15
    s_cselect_b32 s61, 0xff, -1
    s_mov_b32 s60, -1
    s_cmp_ge_u32 s48, 8
    s_cselect_b32 s78, 0x00ff00ff, -1
    s_mov_b32 s79, s78

    v_and_b32 v116, 0xffc, v0
    v_and_b32 v8, 3, v0
    s_movk_i32 s64, 544
    v_lshlrev_b32 v118, 12, v116
    v_mad_u32_u24 v117, v8, s64, v116
    v_lshl_or_b32 v118, v8, 4, v118

    s_and_b32 s66, s48, 3
    s_lshr_b32 s67, s48, 2
    s_lshl_b32 s64, s66, 6
    s_lshl_b32 s65, s67, 12
    s_mul_i32 s68, s67, 4352
    s_add_u32 s68, s68, s64
    s_mul_i32 s69, s54, 10240
    s_add_u32 s69, s69, s65
    s_add_u32 s69, s69, s64
    s_mul_i32 s70, s77, 0
    s_and_b32 s71, s48, 1
    s_lshl_b32 s71, s71, 5
    s_lshr_b32 s75, s2, 3
    s_mul_i32 s75, s75, 80000
    s_lshl_b32 s72, s48, 13
    s_add_u32 s75, s75, s72
    s_add_u32 s75, s75, 0
    s_waitcnt lgkmcnt(0)
    v_xor_b32 v120, s64, v120
    v_add_u32 v121, s65, v121
    v_add_u32 v122, s68, v122
    v_add_u32 v123, s69, v123
    v_add_u32 v124, s70, v124
    v_add_u32 v125, s70, v125
    v_add_u32 v126, s70, v126
    v_xor_b32 v10, s71, v127
    v_xor_b32 v127, 32, v120
    v_xor_b32 v32, 64, v121
    v_xor_b32 v33, 0x80, v121
    v_xor_b32 v34, 0xc0, v121
    s_cmp_ge_u32 s48, 10
    s_cbranch_scc1 L_nobin

    s_movk_i32 s65, -80
    s_movk_i32 s66, 544
    s_cmp_lg_u32 s48, 0
    s_cbranch_scc1 L_notfw
    s_add_u32 s64, s59, 1
    s_and_b32 s64, s64, 0x3fffff
    v_mov_b32 v31, s64
    v_mov_b32 v8, 0

    s_lshr_b32 s67, s2, 2
    s_mul_i32 s67, s67, 64
    s_and_b32 s64, s2, 3
    s_lshl_b32 s64, s64, 2
    s_add_u32 s67, s67, s64
    s_add_u32 s67, s67, 33554432
    s_mov_b64 exec, 1
    ds_write_b32 v8, v31 offset:512

    s_waitcnt vmcnt(0)

    buffer_store_dword v31, v8, s[44:47], s67 offen sc1
    s_mov_b64 exec, -1
    s_branch L_bin
    L_notfw:

    s_waitcnt vmcnt(0)
    L_bin:

    v_mul_u32_u24 v24, 52429, v20
    v_lshrrev_b32 v24, 22, v24
    v_lshlrev_b32 v26, 2, v24
    ds_add_rtn_u32 v28, v26, v2 offset:0

    v_mul_u32_u24 v25, 52429, v21
    v_lshrrev_b32 v25, 22, v25
    v_lshlrev_b32 v27, 2, v25
    ds_add_rtn_u32 v29, v27, v2 offset:0

    v_mad_i32_i24 v24, v24, s65, v20
    v_lshl_or_b32 v22, v22, 7, v24

    v_mad_i32_i24 v25, v25, s65, v21
    v_lshl_or_b32 v23, v23, 7, v25

    s_waitcnt lgkmcnt(1)
    v_min_u32 v28, 40, v28
    v_mad_u32_u24 v28, v28, s66, v26
    ds_write_b32 v28, v22 offset:6144

    s_waitcnt lgkmcnt(1)
    v_min_u32 v29, 40, v29
    v_mad_u32_u24 v29, v29, s66, v27
    ds_write_b32 v29, v23 offset:6144

    L_nobin:
    v_mov_b32 v9, 0

    s_waitcnt lgkmcnt(0)
    s_barrier

    ds_read_b32 v31, v9 offset:512

    s_cmp_ge_u32 s48, 8
    s_cbranch_scc1 L_nopack
    ds_read_b32 v20, v117 offset:6144
    ds_read_b32 v21, v117 offset:8320
    ds_read_b32 v22, v117 offset:10496
    ds_read_b32 v23, v117 offset:12672
    ds_read_b32 v24, v117 offset:14848
    ds_read_b32 v26, v116 offset:0
    s_cmp_eq_u32 s48, 7
    s_cselect_b32 s65, 0xfffff, -1
    s_mov_b32 s64, -1
    s_lshl_b32 s66, s2, 6
    s_add_u32 s66, s66, 4096

    s_waitcnt lgkmcnt(0)
    v_cmp_lt_u32 vcc, 20, v26
    v_lshrrev_b32 v13, 9, v20
    v_lshrrev_b32 v14, 20, v21
    v_cndmask_b32 v12, 0, 1, vcc
    v_lshrrev_b32 v15, 10, v23
    v_lshl_or_b32 v13, v21, 12, v13
    v_lshl_or_b32 v12, v12, 22, v31
    v_lshl_or_b32 v14, v22, 1, v14
    v_lshl_or_b32 v15, v24, 11, v15
    v_lshl_or_b32 v12, v20, 23, v12
    v_lshl_or_b32 v14, v23, 22, v14
    s_and_b64 s[68:69], vcc, s[64:65]
    s_mov_b64 exec, s[64:65]
    buffer_store_dwordx4 v[12:15], v118, s[44:47], s66 offen sc1
    s_cbranch_scc1 L_storeB
    L_storeB_done:
    s_mov_b64 exec, -1

    s_branch L_nopack1
    L_nopack:
    s_cmp_lg_u32 s48, 8
    s_cbranch_scc1 L_gpf_1
    s_lshr_b32 s64, s2, 3
    s_mul_i32 s64, s64, 80000
    v_lshlrev_b32 v8, 7, v1

    s_and_b32 s19, s2, 7
    s_mul_i32 s19, s19, 8
    s_lshr_b32 s19, s19, 3
    s_add_u32 s19, s19, 0
    s_cmp_ge_u32 s19, 10
    s_cselect_b32 s18, 10, 0
    s_sub_u32 s19, s19, s18
    s_lshl_b32 s19, s19, 13
    s_add_u32 s19, s19, s64
    buffer_load_dword v20, v8, s[20:23], s19 offen

L_gpf_1:
    s_cmp_lg_u32 s48, 9
    s_cbranch_scc1 L_gpf_2
    s_lshr_b32 s64, s2, 3
    s_mul_i32 s64, s64, 80000
    v_lshlrev_b32 v8, 7, v1

    s_and_b32 s19, s2, 7
    s_mul_i32 s19, s19, 8
    s_lshr_b32 s19, s19, 3
    s_add_u32 s19, s19, 1
    s_cmp_ge_u32 s19, 10
    s_cselect_b32 s18, 10, 0
    s_sub_u32 s19, s19, s18
    s_lshl_b32 s19, s19, 13
    s_add_u32 s19, s19, s64
    buffer_load_dword v20, v8, s[20:23], s19 offen

L_gpf_2:
    L_nopack1:

    s_cmp_lt_u32 s48, 10
    s_cbranch_scc1 L_b3

    s_mov_b32 s14, 0x81797100
    s_mov_b32 s15, 0xa191
    s_sub_u32 s18, s48, 10
    s_lshl_b32 s18, s18, 3
    s_lshr_b64 s[14:15], s[14:15], s18
    s_and_b32 s12, s14, 0xff
    s_bfe_u32 s13, s14, 0x80008
    s_cmp_eq_u32 s48, 15
    s_cselect_b32 s13, -1, s13

    s_waitcnt vmcnt(0)

    L_b3:
    s_barrier

    s_cmp_ge_u32 s48, 12
    s_cbranch_scc1 L_noq

    ds_read_b64_tr_b16 v[56:57], v120 offset:0
    ds_read_b64_tr_b16 v[58:59], v120 offset:1024
    ds_read_b64_tr_b16 v[72:73], v127 offset:0
    ds_read_b64_tr_b16 v[74:75], v127 offset:1024
    ds_read_b64_tr_b16 v[60:61], v120 offset:8192
    ds_read_b64_tr_b16 v[62:63], v120 offset:9216
    ds_read_b64_tr_b16 v[76:77], v127 offset:8192
    ds_read_b64_tr_b16 v[78:79], v127 offset:9216
    ds_read_b64_tr_b16 v[64:65], v120 offset:16384
    ds_read_b64_tr_b16 v[66:67], v120 offset:17408
    ds_read_b64_tr_b16 v[80:81], v127 offset:16384
    ds_read_b64_tr_b16 v[82:83], v127 offset:17408
    ds_read_b64_tr_b16 v[68:69], v120 offset:24576
    ds_read_b64_tr_b16 v[70:71], v120 offset:25600
    ds_read_b64_tr_b16 v[84:85], v127 offset:24576
    ds_read_b64_tr_b16 v[86:87], v127 offset:25600
    ds_read_b128 v[88:91], v121
    ds_read_b128 v[92:95], v32
    ds_read_b128 v[96:99], v33
    ds_read_b128 v[100:103], v34
    s_waitcnt lgkmcnt(3)
    v_mfma_f32_16x16x32_bf16 v[104:107], v[56:59], v[88:91], 0
    v_mfma_f32_16x16x32_bf16 v[108:111], v[72:75], v[88:91], 0
    s_waitcnt lgkmcnt(2)
    v_mfma_f32_16x16x32_bf16 v[104:107], v[60:63], v[92:95], v[104:107]
    v_mfma_f32_16x16x32_bf16 v[108:111], v[76:79], v[92:95], v[108:111]
    s_waitcnt lgkmcnt(1)
    v_mfma_f32_16x16x32_bf16 v[104:107], v[64:67], v[96:99], v[104:107]
    v_mfma_f32_16x16x32_bf16 v[108:111], v[80:83], v[96:99], v[108:111]
    s_waitcnt lgkmcnt(0)
    v_mfma_f32_16x16x32_bf16 v[104:107], v[68:71], v[100:103], v[104:107]
    v_mfma_f32_16x16x32_bf16 v[108:111], v[84:87], v[100:103], v[108:111]
    s_nop 7
    s_nop 1

    v_cvt_pk_bf16_f32 v112, v104, v105
    v_cvt_pk_bf16_f32 v114, v108, v109
    v_cvt_pk_bf16_f32 v113, v106, v107
    v_cvt_pk_bf16_f32 v115, v110, v111
    s_nop 0
    v_permlane32_swap_b32 v112, v114
    v_permlane32_swap_b32 v113, v115
    s_nop 0
    v_permlane16_swap_b32 v112, v114
    v_permlane16_swap_b32 v113, v115

    s_mov_b64 exec, s[78:79]
    ds_write_b128 v122, v[112:115] offset:6144
    s_mov_b64 exec, -1

    s_branch L_gdone
    L_noq:
    s_cmp_eq_u32 s48, 12
    s_cbranch_scc1 L_nowv3
    s_sub_u32 s66, s48, 12
    s_cmp_lg_u32 s48, 13
    s_cbranch_scc1 L_wv3b
    s_mov_b32 s66, 0

    s_lshr_b32 s64, s2, 3
    s_lshl_b32 s64, s64, 12
    s_lshl_b32 s65, s66, 10
    s_add_u32 s64, s64, s65
    s_and_b32 s64, s64, 0x7fff

    s_add_u32 m0, s64, 75264
    s_add_u32 s65, s64, 4096
    buffer_load_dwordx4 v24, s[36:39], s64 offen lds
    s_and_b32 s64, s65, 0x7fff
    s_add_u32 m0, s64, 75264
    s_add_u32 s65, s64, 4096
    buffer_load_dwordx4 v24, s[36:39], s64 offen lds
    s_and_b32 s64, s65, 0x7fff
    s_add_u32 m0, s64, 75264
    s_add_u32 s65, s64, 4096
    buffer_load_dwordx4 v24, s[36:39], s64 offen lds
    s_and_b32 s64, s65, 0x7fff
    s_add_u32 m0, s64, 75264
    s_add_u32 s65, s64, 4096
    buffer_load_dwordx4 v24, s[36:39], s64 offen lds
    s_and_b32 s64, s65, 0x7fff
    s_add_u32 m0, s64, 75264
    s_add_u32 s65, s64, 4096
    buffer_load_dwordx4 v24, s[36:39], s64 offen lds
    s_and_b32 s64, s65, 0x7fff
    s_add_u32 m0, s64, 75264
    s_add_u32 s65, s64, 4096
    buffer_load_dwordx4 v24, s[36:39], s64 offen lds
    s_and_b32 s64, s65, 0x7fff
    s_add_u32 m0, s64, 75264
    s_add_u32 s65, s64, 4096
    buffer_load_dwordx4 v24, s[36:39], s64 offen lds
    s_and_b32 s64, s65, 0x7fff
    s_add_u32 m0, s64, 75264
    s_nop 0
    buffer_load_dwordx4 v24, s[36:39], s64 offen lds
    s_mov_b32 s66, 1
    L_wv3b:
    s_lshr_b32 s64, s2, 3
    s_lshl_b32 s64, s64, 12
    s_lshl_b32 s65, s66, 10
    s_add_u32 s64, s64, s65
    s_and_b32 s64, s64, 0x7fff

    s_add_u32 m0, s64, 75264
    s_add_u32 s65, s64, 4096
    buffer_load_dwordx4 v24, s[36:39], s64 offen lds
    s_and_b32 s64, s65, 0x7fff
    s_add_u32 m0, s64, 75264
    s_add_u32 s65, s64, 4096
    buffer_load_dwordx4 v24, s[36:39], s64 offen lds
    s_and_b32 s64, s65, 0x7fff
    s_add_u32 m0, s64, 75264
    s_add_u32 s65, s64, 4096
    buffer_load_dwordx4 v24, s[36:39], s64 offen lds
    s_and_b32 s64, s65, 0x7fff
    s_add_u32 m0, s64, 75264
    s_add_u32 s65, s64, 4096
    buffer_load_dwordx4 v24, s[36:39], s64 offen lds
    s_and_b32 s64, s65, 0x7fff
    s_add_u32 m0, s64, 75264
    s_add_u32 s65, s64, 4096
    buffer_load_dwordx4 v24, s[36:39], s64 offen lds
    s_and_b32 s64, s65, 0x7fff
    s_add_u32 m0, s64, 75264
    s_add_u32 s65, s64, 4096
    buffer_load_dwordx4 v24, s[36:39], s64 offen lds
    s_and_b32 s64, s65, 0x7fff
    s_add_u32 m0, s64, 75264
    s_add_u32 s65, s64, 4096
    buffer_load_dwordx4 v24, s[36:39], s64 offen lds
    s_and_b32 s64, s65, 0x7fff
    s_add_u32 m0, s64, 75264
    s_nop 0
    buffer_load_dwordx4 v24, s[36:39], s64 offen lds
    L_nowv3:
    s_cmp_lg_u32 s48, 14
    s_cbranch_scc1 L_gpf_3
    s_lshr_b32 s64, s2, 3
    s_mul_i32 s64, s64, 80000
    v_lshlrev_b32 v8, 7, v1

    s_and_b32 s19, s2, 7
    s_mul_i32 s19, s19, 8
    s_lshr_b32 s19, s19, 3
    s_add_u32 s19, s19, 2
    s_cmp_ge_u32 s19, 10
    s_cselect_b32 s18, 10, 0
    s_sub_u32 s19, s19, s18
    s_lshl_b32 s19, s19, 13
    s_add_u32 s19, s19, s64
    buffer_load_dword v60, v8, s[20:23], s19 offen

L_gpf_3:
    s_cmp_lg_u32 s48, 15
    s_cbranch_scc1 L_gpf_4
    s_lshr_b32 s64, s2, 3
    s_mul_i32 s64, s64, 80000
    v_lshlrev_b32 v8, 7, v1

    s_and_b32 s19, s2, 7
    s_mul_i32 s19, s19, 8
    s_lshr_b32 s19, s19, 3
    s_add_u32 s19, s19, 3
    s_cmp_ge_u32 s19, 10
    s_cselect_b32 s18, 10, 0
    s_sub_u32 s19, s19, s18
    s_lshl_b32 s19, s19, 13
    s_add_u32 s19, s19, s64
    buffer_load_dword v60, v8, s[20:23], s19 offen

L_gpf_4:
    s_cmp_lg_u32 s48, 12
    s_cbranch_scc1 L_gdone
    v_lshrrev_b32 v26, 1, v1
    v_mul_u32_u24 v26, 1280, v26
    v_and_b32 v27, 1, v1
    v_mul_u32_u24 v27, 64, v27
    v_add_u32 v26, v26, v27

    s_add_u32 s74, 33554432, 0
    s_mov_b32 s66, 0xff
    s_mov_b32 s67, 0x0
    s_mov_b32 s72, -1
    s_mov_b32 s73, 0x3fffffff
    s_waitcnt lgkmcnt(0)
    s_mov_b64 exec, s[66:67]

    L_gate:
    buffer_load_dwordx4 v[12:15], v26, s[44:47], s74 offen sc1
    s_sub_u32 s55, s55, 1
    s_cbranch_scc1 L_gx
    L_gate1:

    s_waitcnt vmcnt(0)
    v_cmp_ne_u32 s[66:67], v31, v12
    v_cmp_ne_u32 s[68:69], v31, v13
    v_cmp_ne_u32 s[70:71], v31, v14
    v_cmp_ne_u32 vcc, v31, v15
    s_or_b64 s[66:67], s[66:67], s[68:69]
    s_or_b64 s[70:71], s[70:71], vcc
    s_or_b64 s[66:67], s[66:67], s[70:71]

    s_cbranch_scc1 L_gate
    L_gx:

    s_mov_b32 s55, 30000
    s_mov_b64 exec, -1

L_gdone:
    s_lshr_b32 s66, s54, 1
    s_lshl_b32 s66, s66, 14
    s_add_u32 s66, s66, 4096
    s_bitcmp1_b32 s54, 0
    s_cselect_b32 s64, -160, 0
    s_movk_i32 s65, 160

    s_waitcnt lgkmcnt(0)
    s_barrier
    s_mov_b64 exec, s[60:61]

    buffer_load_dwordx4 v[12:15], v119, s[44:47], s66 offen
    s_branch L_poll1

    L_poll:
    buffer_load_dwordx4 v[12:15], v119, s[44:47], s66 offen sc1
    L_poll1:
    s_sub_u32 s55, s55, 1
    s_cbranch_scc1 L_timeout
    s_waitcnt vmcnt(0)
    L_poll2:
    v_and_b32 v16, 0x3fffff, v12
    v_cmp_ne_u32 vcc, v31, v16

    s_wqm_b64 exec, vcc
    s_cbranch_scc1 L_poll
    s_mov_b64 exec, s[60:61]

    v_and_b32 v16, 0x400000, v12
    v_cmp_ne_u32 s[10:11], 0, v16

    s_cmp_lg_u64 s[10:11], 0
    s_cbranch_scc1 L_issueB
    L_issueB_done:

    v_alignbit_b32 v20, v13, v12, 22
    v_alignbit_b32 v21, v14, v13, 11
    v_alignbit_b32 v23, v15, v14, 21
    v_lshrrev_b32 v24, 10, v15

    v_and_b32 v26, 0xfe, v20
    v_and_b32 v27, 0xfe, v21
    v_and_b32 v28, 0xfe, v14
    v_and_b32 v29, 0xfe, v23
    v_and_b32 v30, 0xfe, v24
    v_lshl_add_u32 v26, v26, 1, s64
    v_lshl_add_u32 v27, v27, 1, s64
    v_lshl_add_u32 v28, v28, 1, s64
    v_lshl_add_u32 v29, v29, 1, s64
    v_lshl_add_u32 v30, v30, 1, s64
    v_cmp_gt_u32 s[68:69], s65, v26
    v_cmp_gt_u32 s[70:71], s65, v27
    v_cmp_gt_u32 s[72:73], s65, v28
    v_cmp_gt_u32 s[74:75], s65, v29
    v_cmp_gt_u32 s[8:9], s65, v30
    s_mov_b64 exec, s[68:69]
    ds_add_rtn_u32 v32, v26, v3 offset:1024

    s_mov_b64 exec, s[70:71]
    ds_add_rtn_u32 v33, v27, v3 offset:1024

    s_mov_b64 exec, s[72:73]
    ds_add_rtn_u32 v34, v28, v3 offset:1024

    s_mov_b64 exec, s[74:75]
    ds_add_rtn_u32 v35, v29, v3 offset:1024

    s_mov_b64 exec, s[8:9]
    ds_add_rtn_u32 v36, v30, v3 offset:1024

    s_mov_b64 exec, s[68:69]
    s_waitcnt lgkmcnt(4)
    ds_write_b32 v32, v20

    s_mov_b64 exec, s[70:71]
    s_waitcnt lgkmcnt(4)
    ds_write_b32 v33, v21

    s_mov_b64 exec, s[72:73]
    s_waitcnt lgkmcnt(4)
    ds_write_b32 v34, v14

    s_mov_b64 exec, s[74:75]
    s_waitcnt lgkmcnt(4)
    ds_write_b32 v35, v23

    s_mov_b64 exec, s[8:9]
    s_waitcnt lgkmcnt(4)
    ds_write_b32 v36, v24

    L_A_done:
    s_mov_b64 exec, -1
    s_waitcnt lgkmcnt(0)
    s_barrier

    s_cmp_lt_u32 s48, 10
    s_cbranch_scc1 L_noperm
    v_lshlrev_b32 v8, 2, v1
    ds_read_b32 v16, v8 offset:1024
    s_setprio 3
    v_mul_u32_u24 v17, 272, v1
    v_lshl_or_b32 v17, v1, 16, v17
    v_or_b32 v17, 0x80000000, v17
    s_mov_b32 exec_hi, 0xff
    s_waitcnt lgkmcnt(0)
    v_sub_u32 v16, v16, v7
    v_cmp_le_u32 s[4:5], s12, v16
    v_cmp_le_u32 s[6:7], s13, v16
    s_bcnt1_i32_b64 s18, s[4:5]
    s_sub_u32 s18, 40, s18
    v_mov_b32 v18, s18
    s_andn2_b64 exec, s[4:5], s[6:7]
    v_mbcnt_lo_u32_b32 v18, exec_lo, v18
    v_mbcnt_hi_u32_b32 v18, exec_hi, v18
    v_lshlrev_b32 v18, 2, v18
    ds_write_b32 v18, v17 offset:640
    s_mov_b64 exec, -1
    s_setprio 0

    L_noperm:
    s_cmp_lg_u64 s[10:11], 0
    s_cbranch_scc1 L_pollB
    s_branch L_poll_done
    L_timeout:

    s_waitcnt vmcnt(0) lgkmcnt(0)
    s_mov_b64 exec, 1
    v_mov_b32 v8, 1276
    v_mov_b32 v9, 0x7fffffff
    ds_write_b32 v8, v9
    v_mov_b32 v8, 0
    v_mov_b32 v9, 1
    buffer_atomic_add v9, v8, s[44:47], 0 offen

    s_mov_b64 s[10:11], 0
    s_branch L_A_done
    L_timeoutB:

    s_waitcnt vmcnt(0) lgkmcnt(0)
    s_mov_b64 exec, 1
    v_mov_b32 v8, 1276
    v_mov_b32 v9, 0x7fffffff
    ds_write_b32 v8, v9
    v_mov_b32 v8, 0
    v_mov_b32 v9, 1
    buffer_atomic_add v9, v8, s[44:47], 0 offen

    L_poll_done:
    s_mov_b64 exec, -1

    s_lshl_b32 s72, s48, 3
    s_add_u32 s73, s72, 672
    s_lshl_b32 s72, s72, 1
    s_add_u32 s72, s72, 640

    s_cmp_eq_u32 s76, 2
    s_cselect_b32 s72, s72, s73
    v_bfe_u32 v9, v1, 3, s76
    v_lshl_add_u32 v9, v9, 2, s72

    s_cmp_eq_u32 s76, 2
    s_cselect_b32 s70, 32, 64
    s_mov_b32 s71, 0x3fff00

    s_waitcnt lgkmcnt(0)
    s_barrier

    ds_read_b32 v16, v9
    s_waitcnt lgkmcnt(0)

    v_and_b32 v17, 0xffff, v16
    v_bfe_u32 v16, v16, 16, 6
    v_add_u32 v125, v125, v17
    v_add_u32 v124, v124, v17

    v_add_u32 v126, v126, v17
    v_readlane_b32 s72, v16, 0
    v_readlane_b32 s73, v16, 8
    v_readlane_b32 s74, v16, 16
    v_readlane_b32 s75, v16, 24

    L_main_setup:
    v_lshlrev_b32 v8, 2, v1
    v_mov_b32 v2, v125
    ds_read_b32 v3, v8 offset:1024

    s_cmp_eq_u32 s76, 2
    s_cbranch_scc0 L_rl_5
    ds_read2_b32 v[12:13], v2 offset0:0 offset1:2
    ds_read2_b32 v[14:15], v2 offset0:4 offset1:6
    s_branch L_rl_6

L_rl_5:
    ds_read2_b32 v[12:13], v2 offset0:0 offset1:4
    ds_read2_b32 v[14:15], v2 offset0:8 offset1:12

L_rl_6:
    v_add_u32 v2, s70, v2
    ds_read_b128 v[32:35], v124 offset:6144
    ds_read_b128 v[36:39], v124 offset:6272
    s_movk_i32 s67, 256
    s_waitcnt lgkmcnt(2)

    v_and_or_b32 v16, v12, s71, v4
    v_and_or_b32 v17, v13, s71, v4
    v_and_or_b32 v18, v14, s71, v4
    v_and_or_b32 v19, v15, s71, v4
    v_sub_u32 v3, v3, v7
    v_cmp_lt_u32 vcc, s67, v3
    s_cbranch_vccnz L_slow
    s_cmp_eq_u32 s76, 2
    s_cbranch_scc0 L_rl_7
    ds_read2_b32 v[12:13], v2 offset0:0 offset1:2
    ds_read2_b32 v[14:15], v2 offset0:4 offset1:6
    s_branch L_rl_8

L_rl_7:
    ds_read2_b32 v[12:13], v2 offset0:0 offset1:4
    ds_read2_b32 v[14:15], v2 offset0:8 offset1:12

L_rl_8:
    v_add_u32 v2, s70, v2
    buffer_load_dwordx4 v[56:59], v16, s[20:23], 0 offen
    buffer_load_dwordx4 v[60:63], v16, s[20:23], 0 offen offset:128
    buffer_load_dwordx4 v[64:67], v17, s[20:23], 0 offen
    buffer_load_dwordx4 v[68:71], v17, s[20:23], 0 offen offset:128
    buffer_load_dwordx4 v[72:75], v18, s[20:23], 0 offen
    buffer_load_dwordx4 v[76:79], v18, s[20:23], 0 offen offset:128
    buffer_load_dwordx4 v[80:83], v19, s[20:23], 0 offen
    buffer_load_dwordx4 v[84:87], v19, s[20:23], 0 offen offset:128
    v_readlane_b32 s66, v3, s72
    v_readlane_b32 s67, v3, s73
    v_readlane_b32 s64, v3, s74
    v_readlane_b32 s65, v3, s75
    s_max_u32 s66, s66, s67
    s_max_u32 s64, s64, s65
    s_max_u32 s66, s66, s64
    s_cmp_eq_u32 s76, 1
    s_cbranch_scc1 L_cnt2

    s_add_u32 s66, s66, 4
    s_lshr_b32 s66, s66, 3
    s_branch L_cnt_done
    L_cnt2:
    s_add_u32 s66, s66, 12
    s_lshr_b32 s66, s66, 4
    L_cnt_done:
    s_add_u32 s49, s66, 3
    s_lshr_b32 s49, s49, 2
    s_and_b32 s68, s66, 3
    s_mov_b32 s50, 1

    s_setprio 3
L_loop:
    s_cmp_ge_u32 s50, s49
    s_cbranch_scc1 L_last4_A
    s_cmp_lg_u32 s50, 3
    s_cbranch_scc1 L_p_9
    s_setprio 1
L_p_9:
    s_add_u32 s50, s50, 1
    s_cmp_eq_u32 s50, s49
    s_cselect_b32 s69, s68, 0
    s_waitcnt lgkmcnt(0)

    v_and_or_b32 v16, v12, s71, v4
    v_and_or_b32 v17, v13, s71, v4
    v_and_or_b32 v18, v14, s71, v4
    v_and_or_b32 v19, v15, s71, v4
    s_cmp_eq_u32 s76, 2
    s_cbranch_scc0 L_rl_10
    ds_read2_b32 v[12:13], v2 offset0:0 offset1:2
    ds_read2_b32 v[14:15], v2 offset0:4 offset1:6
    s_branch L_rl_11

L_rl_10:
    ds_read2_b32 v[12:13], v2 offset0:0 offset1:4
    ds_read2_b32 v[14:15], v2 offset0:8 offset1:12

L_rl_11:
    v_add_u32 v2, s70, v2
    buffer_load_dwordx4 v[88:91], v16, s[20:23], 0 offen
    buffer_load_dwordx4 v[92:95], v16, s[20:23], 0 offen offset:128
    s_cmp_eq_u32 s69, 1
    s_cbranch_scc1 L_w1A
    buffer_load_dwordx4 v[96:99], v17, s[20:23], 0 offen
    buffer_load_dwordx4 v[100:103], v17, s[20:23], 0 offen offset:128
    s_cmp_eq_u32 s69, 2
    s_cbranch_scc1 L_w2A
    buffer_load_dwordx4 v[104:107], v18, s[20:23], 0 offen
    buffer_load_dwordx4 v[108:111], v18, s[20:23], 0 offen offset:128
    s_cmp_eq_u32 s69, 3
    s_cbranch_scc1 L_w3A
    buffer_load_dwordx4 v[112:115], v19, s[20:23], 0 offen
    buffer_load_dwordx4 v[116:119], v19, s[20:23], 0 offen offset:128
    s_waitcnt vmcnt(8)
L_goA:
    v_dot2_f32_bf16 v20, v56, v32, 0
    v_dot2_f32_bf16 v21, v64, v32, 0
    v_dot2_f32_bf16 v22, v72, v32, 0
    v_dot2_f32_bf16 v23, v80, v32, 0
    v_dot2c_f32_bf16 v20, v57, v33
    v_dot2c_f32_bf16 v21, v65, v33
    v_dot2c_f32_bf16 v22, v73, v33
    v_dot2c_f32_bf16 v23, v81, v33
    v_dot2c_f32_bf16 v20, v58, v34
    v_dot2c_f32_bf16 v21, v66, v34
    v_dot2c_f32_bf16 v22, v74, v34
    v_dot2c_f32_bf16 v23, v82, v34
    v_dot2c_f32_bf16 v20, v59, v35
    v_dot2c_f32_bf16 v21, v67, v35
    v_dot2c_f32_bf16 v22, v75, v35
    v_dot2c_f32_bf16 v23, v83, v35
    v_dot2c_f32_bf16 v20, v60, v36
    v_dot2c_f32_bf16 v21, v68, v36
    v_dot2c_f32_bf16 v22, v76, v36
    v_dot2c_f32_bf16 v23, v84, v36
    v_dot2c_f32_bf16 v20, v61, v37
    v_dot2c_f32_bf16 v21, v69, v37
    v_dot2c_f32_bf16 v22, v77, v37
    v_dot2c_f32_bf16 v23, v85, v37
    v_dot2c_f32_bf16 v20, v62, v38
    v_dot2c_f32_bf16 v21, v70, v38
    v_dot2c_f32_bf16 v22, v78, v38
    v_dot2c_f32_bf16 v23, v86, v38
    v_dot2c_f32_bf16 v20, v63, v39
    v_dot2c_f32_bf16 v22, v79, v39
    v_dot2c_f32_bf16 v21, v71, v39
    v_dot2c_f32_bf16 v23, v87, v39
    v_add_f32_dpp v24, v20, v20 row_half_mirror row_mask:0xf bank_mask:0x5
    v_add_f32_dpp v24, v22, v22 row_half_mirror row_mask:0xf bank_mask:0xa
    v_add_f32_dpp v25, v21, v21 row_half_mirror row_mask:0xf bank_mask:0x5
    v_add_f32_dpp v25, v23, v23 row_half_mirror row_mask:0xf bank_mask:0xa
    v_add_f32_dpp v26, v24, v24 quad_perm:[1,0,3,2] row_mask:0xf bank_mask:0xf
    s_nop 0
    v_add_f32_dpp v27, v25, v25 quad_perm:[1,0,3,2] row_mask:0xf bank_mask:0xf
    v_cndmask_b32 v26, v26, v27, s[52:53]
    s_nop 1

    v_add_f32_dpp v27, v26, v26 quad_perm:[2,3,0,1] row_mask:0xf bank_mask:0xf
    v_mul_f32 v27, s51, v27
    v_exp_f32 v27, v27
    s_nop 0
    v_add_f32 v27, 1.0, v27
    v_rcp_f32 v27, v27
    s_nop 0
    v_cvt_pk_bf16_f32 v26, v27, v27
    s_nop 1
    v_and_b32_dpp v28, v26, v5 quad_perm:[0,0,0,0] row_mask:0xf bank_mask:0xf
    v_and_b32_dpp v29, v26, v6 quad_perm:[0,0,0,0] row_mask:0xf bank_mask:0xf

    v_and_b32_dpp v30, v26, v5 quad_perm:[1,1,1,1] row_mask:0xf bank_mask:0xf
    v_and_b32_dpp v31, v26, v6 quad_perm:[1,1,1,1] row_mask:0xf bank_mask:0xf

    v_mfma_f32_4x4x4_16b_bf16 v[40:43], v[28:29], v[56:57], v[40:43] cbsz:1 abid:0
    v_mfma_f32_4x4x4_16b_bf16 v[44:47], v[28:29], v[58:59], v[44:47] cbsz:1 abid:0
    v_mfma_f32_4x4x4_16b_bf16 v[48:51], v[28:29], v[60:61], v[48:51] cbsz:1 abid:0
    v_mfma_f32_4x4x4_16b_bf16 v[52:55], v[28:29], v[62:63], v[52:55] cbsz:1 abid:0
    v_mfma_f32_4x4x4_16b_bf16 v[40:43], v[28:29], v[72:73], v[40:43] cbsz:1 abid:1
    v_mfma_f32_4x4x4_16b_bf16 v[44:47], v[28:29], v[74:75], v[44:47] cbsz:1 abid:1
    v_mfma_f32_4x4x4_16b_bf16 v[48:51], v[28:29], v[76:77], v[48:51] cbsz:1 abid:1
    v_mfma_f32_4x4x4_16b_bf16 v[52:55], v[28:29], v[78:79], v[52:55] cbsz:1 abid:1
    v_mfma_f32_4x4x4_16b_bf16 v[40:43], v[30:31], v[64:65], v[40:43] cbsz:1 abid:0
    v_mfma_f32_4x4x4_16b_bf16 v[44:47], v[30:31], v[66:67], v[44:47] cbsz:1 abid:0
    v_mfma_f32_4x4x4_16b_bf16 v[48:51], v[30:31], v[68:69], v[48:51] cbsz:1 abid:0
    v_mfma_f32_4x4x4_16b_bf16 v[52:55], v[30:31], v[70:71], v[52:55] cbsz:1 abid:0
    v_mfma_f32_4x4x4_16b_bf16 v[40:43], v[30:31], v[80:81], v[40:43] cbsz:1 abid:1
    v_mfma_f32_4x4x4_16b_bf16 v[44:47], v[30:31], v[82:83], v[44:47] cbsz:1 abid:1
    v_mfma_f32_4x4x4_16b_bf16 v[48:51], v[30:31], v[84:85], v[48:51] cbsz:1 abid:1
    v_mfma_f32_4x4x4_16b_bf16 v[52:55], v[30:31], v[86:87], v[52:55] cbsz:1 abid:1
    s_cmp_lg_u32 s69, 0
    s_cbranch_scc1 L_part_A
    s_cmp_ge_u32 s50, s49
    s_cbranch_scc1 L_last4_B
    s_cmp_lg_u32 s50, 2
    s_cbranch_scc1 L_p_12
    s_setprio 2
L_p_12:
    s_cmp_lg_u32 s50, 4
    s_cbranch_scc1 L_p_13
    s_setprio 0
L_p_13:
    s_add_u32 s50, s50, 1
    s_cmp_eq_u32 s50, s49
    s_cselect_b32 s69, s68, 0
    s_waitcnt lgkmcnt(0)

    v_and_or_b32 v16, v12, s71, v4
    v_and_or_b32 v17, v13, s71, v4
    v_and_or_b32 v18, v14, s71, v4
    v_and_or_b32 v19, v15, s71, v4
    s_cmp_eq_u32 s76, 2
    s_cbranch_scc0 L_rl_14
    ds_read2_b32 v[12:13], v2 offset0:0 offset1:2
    ds_read2_b32 v[14:15], v2 offset0:4 offset1:6
    s_branch L_rl_15

L_rl_14:
    ds_read2_b32 v[12:13], v2 offset0:0 offset1:4
    ds_read2_b32 v[14:15], v2 offset0:8 offset1:12

L_rl_15:
    v_add_u32 v2, s70, v2
    buffer_load_dwordx4 v[56:59], v16, s[20:23], 0 offen
    buffer_load_dwordx4 v[60:63], v16, s[20:23], 0 offen offset:128
    s_cmp_eq_u32 s69, 1
    s_cbranch_scc1 L_w1B
    buffer_load_dwordx4 v[64:67], v17, s[20:23], 0 offen
    buffer_load_dwordx4 v[68:71], v17, s[20:23], 0 offen offset:128
    s_cmp_eq_u32 s69, 2
    s_cbranch_scc1 L_w2B
    buffer_load_dwordx4 v[72:75], v18, s[20:23], 0 offen
    buffer_load_dwordx4 v[76:79], v18, s[20:23], 0 offen offset:128
    s_cmp_eq_u32 s69, 3
    s_cbranch_scc1 L_w3B
    buffer_load_dwordx4 v[80:83], v19, s[20:23], 0 offen
    buffer_load_dwordx4 v[84:87], v19, s[20:23], 0 offen offset:128
    s_waitcnt vmcnt(8)
L_goB:
    v_dot2_f32_bf16 v20, v88, v32, 0
    v_dot2_f32_bf16 v21, v96, v32, 0
    v_dot2_f32_bf16 v22, v104, v32, 0
    v_dot2_f32_bf16 v23, v112, v32, 0
    v_dot2c_f32_bf16 v20, v89, v33
    v_dot2c_f32_bf16 v21, v97, v33
    v_dot2c_f32_bf16 v22, v105, v33
    v_dot2c_f32_bf16 v23, v113, v33
    v_dot2c_f32_bf16 v20, v90, v34
    v_dot2c_f32_bf16 v21, v98, v34
    v_dot2c_f32_bf16 v22, v106, v34
    v_dot2c_f32_bf16 v23, v114, v34
    v_dot2c_f32_bf16 v20, v91, v35
    v_dot2c_f32_bf16 v21, v99, v35
    v_dot2c_f32_bf16 v22, v107, v35
    v_dot2c_f32_bf16 v23, v115, v35
    v_dot2c_f32_bf16 v20, v92, v36
    v_dot2c_f32_bf16 v21, v100, v36
    v_dot2c_f32_bf16 v22, v108, v36
    v_dot2c_f32_bf16 v23, v116, v36
    v_dot2c_f32_bf16 v20, v93, v37
    v_dot2c_f32_bf16 v21, v101, v37
    v_dot2c_f32_bf16 v22, v109, v37
    v_dot2c_f32_bf16 v23, v117, v37
    v_dot2c_f32_bf16 v20, v94, v38
    v_dot2c_f32_bf16 v21, v102, v38
    v_dot2c_f32_bf16 v22, v110, v38
    v_dot2c_f32_bf16 v23, v118, v38
    v_dot2c_f32_bf16 v20, v95, v39
    v_dot2c_f32_bf16 v22, v111, v39
    v_dot2c_f32_bf16 v21, v103, v39
    v_dot2c_f32_bf16 v23, v119, v39
    v_add_f32_dpp v24, v20, v20 row_half_mirror row_mask:0xf bank_mask:0x5
    v_add_f32_dpp v24, v22, v22 row_half_mirror row_mask:0xf bank_mask:0xa
    v_add_f32_dpp v25, v21, v21 row_half_mirror row_mask:0xf bank_mask:0x5
    v_add_f32_dpp v25, v23, v23 row_half_mirror row_mask:0xf bank_mask:0xa
    v_add_f32_dpp v26, v24, v24 quad_perm:[1,0,3,2] row_mask:0xf bank_mask:0xf
    s_nop 0
    v_add_f32_dpp v27, v25, v25 quad_perm:[1,0,3,2] row_mask:0xf bank_mask:0xf
    v_cndmask_b32 v26, v26, v27, s[52:53]
    s_nop 1

    v_add_f32_dpp v27, v26, v26 quad_perm:[2,3,0,1] row_mask:0xf bank_mask:0xf
    v_mul_f32 v27, s51, v27
    v_exp_f32 v27, v27
    s_nop 0
    v_add_f32 v27, 1.0, v27
    v_rcp_f32 v27, v27
    s_nop 0
    v_cvt_pk_bf16_f32 v26, v27, v27
    s_nop 1
    v_and_b32_dpp v28, v26, v5 quad_perm:[0,0,0,0] row_mask:0xf bank_mask:0xf
    v_and_b32_dpp v29, v26, v6 quad_perm:[0,0,0,0] row_mask:0xf bank_mask:0xf

    v_and_b32_dpp v30, v26, v5 quad_perm:[1,1,1,1] row_mask:0xf bank_mask:0xf
    v_and_b32_dpp v31, v26, v6 quad_perm:[1,1,1,1] row_mask:0xf bank_mask:0xf

    v_mfma_f32_4x4x4_16b_bf16 v[40:43], v[28:29], v[88:89], v[40:43] cbsz:1 abid:0
    v_mfma_f32_4x4x4_16b_bf16 v[44:47], v[28:29], v[90:91], v[44:47] cbsz:1 abid:0
    v_mfma_f32_4x4x4_16b_bf16 v[48:51], v[28:29], v[92:93], v[48:51] cbsz:1 abid:0
    v_mfma_f32_4x4x4_16b_bf16 v[52:55], v[28:29], v[94:95], v[52:55] cbsz:1 abid:0
    v_mfma_f32_4x4x4_16b_bf16 v[40:43], v[28:29], v[104:105], v[40:43] cbsz:1 abid:1
    v_mfma_f32_4x4x4_16b_bf16 v[44:47], v[28:29], v[106:107], v[44:47] cbsz:1 abid:1
    v_mfma_f32_4x4x4_16b_bf16 v[48:51], v[28:29], v[108:109], v[48:51] cbsz:1 abid:1
    v_mfma_f32_4x4x4_16b_bf16 v[52:55], v[28:29], v[110:111], v[52:55] cbsz:1 abid:1
    v_mfma_f32_4x4x4_16b_bf16 v[40:43], v[30:31], v[96:97], v[40:43] cbsz:1 abid:0
    v_mfma_f32_4x4x4_16b_bf16 v[44:47], v[30:31], v[98:99], v[44:47] cbsz:1 abid:0
    v_mfma_f32_4x4x4_16b_bf16 v[48:51], v[30:31], v[100:101], v[48:51] cbsz:1 abid:0
    v_mfma_f32_4x4x4_16b_bf16 v[52:55], v[30:31], v[102:103], v[52:55] cbsz:1 abid:0
    v_mfma_f32_4x4x4_16b_bf16 v[40:43], v[30:31], v[112:113], v[40:43] cbsz:1 abid:1
    v_mfma_f32_4x4x4_16b_bf16 v[44:47], v[30:31], v[114:115], v[44:47] cbsz:1 abid:1
    v_mfma_f32_4x4x4_16b_bf16 v[48:51], v[30:31], v[116:117], v[48:51] cbsz:1 abid:1
    v_mfma_f32_4x4x4_16b_bf16 v[52:55], v[30:31], v[118:119], v[52:55] cbsz:1 abid:1
    s_cmp_lg_u32 s69, 0
    s_cbranch_scc1 L_part_B
    s_branch L_loop
L_w1A:
    s_waitcnt vmcnt(2)
    s_branch L_goA
L_w2A:
    s_waitcnt vmcnt(4)
    s_branch L_goA
L_w3A:
    s_waitcnt vmcnt(6)
    s_branch L_goA
L_last4_A:
    s_waitcnt vmcnt(0) lgkmcnt(0)
    v_dot2_f32_bf16 v20, v56, v32, 0
    v_dot2_f32_bf16 v21, v64, v32, 0
    v_dot2_f32_bf16 v22, v72, v32, 0
    v_dot2_f32_bf16 v23, v80, v32, 0
    v_dot2c_f32_bf16 v20, v57, v33
    v_dot2c_f32_bf16 v21, v65, v33
    v_dot2c_f32_bf16 v22, v73, v33
    v_dot2c_f32_bf16 v23, v81, v33
    v_dot2c_f32_bf16 v20, v58, v34
    v_dot2c_f32_bf16 v21, v66, v34
    v_dot2c_f32_bf16 v22, v74, v34
    v_dot2c_f32_bf16 v23, v82, v34
    v_dot2c_f32_bf16 v20, v59, v35
    v_dot2c_f32_bf16 v21, v67, v35
    v_dot2c_f32_bf16 v22, v75, v35
    v_dot2c_f32_bf16 v23, v83, v35
    v_dot2c_f32_bf16 v20, v60, v36
    v_dot2c_f32_bf16 v21, v68, v36
    v_dot2c_f32_bf16 v22, v76, v36
    v_dot2c_f32_bf16 v23, v84, v36
    v_dot2c_f32_bf16 v20, v61, v37
    v_dot2c_f32_bf16 v21, v69, v37
    v_dot2c_f32_bf16 v22, v77, v37
    v_dot2c_f32_bf16 v23, v85, v37
    v_dot2c_f32_bf16 v20, v62, v38
    v_dot2c_f32_bf16 v21, v70, v38
    v_dot2c_f32_bf16 v22, v78, v38
    v_dot2c_f32_bf16 v23, v86, v38
    v_dot2c_f32_bf16 v20, v63, v39
    v_dot2c_f32_bf16 v22, v79, v39
    v_dot2c_f32_bf16 v21, v71, v39
    v_dot2c_f32_bf16 v23, v87, v39
    v_add_f32_dpp v24, v20, v20 row_half_mirror row_mask:0xf bank_mask:0x5
    v_add_f32_dpp v24, v22, v22 row_half_mirror row_mask:0xf bank_mask:0xa
    v_add_f32_dpp v25, v21, v21 row_half_mirror row_mask:0xf bank_mask:0x5
    v_add_f32_dpp v25, v23, v23 row_half_mirror row_mask:0xf bank_mask:0xa
    v_add_f32_dpp v26, v24, v24 quad_perm:[1,0,3,2] row_mask:0xf bank_mask:0xf
    s_nop 0
    v_add_f32_dpp v27, v25, v25 quad_perm:[1,0,3,2] row_mask:0xf bank_mask:0xf
    v_cndmask_b32 v26, v26, v27, s[52:53]
    s_nop 1

    v_add_f32_dpp v27, v26, v26 quad_perm:[2,3,0,1] row_mask:0xf bank_mask:0xf
    v_mul_f32 v27, s51, v27
    v_exp_f32 v27, v27
    s_nop 0
    v_add_f32 v27, 1.0, v27
    v_rcp_f32 v27, v27
    s_nop 0
    v_cvt_pk_bf16_f32 v26, v27, v27
    s_nop 1
    v_and_b32_dpp v28, v26, v5 quad_perm:[0,0,0,0] row_mask:0xf bank_mask:0xf
    v_and_b32_dpp v29, v26, v6 quad_perm:[0,0,0,0] row_mask:0xf bank_mask:0xf

    v_and_b32_dpp v30, v26, v5 quad_perm:[1,1,1,1] row_mask:0xf bank_mask:0xf
    v_and_b32_dpp v31, v26, v6 quad_perm:[1,1,1,1] row_mask:0xf bank_mask:0xf

    v_mfma_f32_4x4x4_16b_bf16 v[40:43], v[28:29], v[56:57], v[40:43] cbsz:1 abid:0
    v_mfma_f32_4x4x4_16b_bf16 v[44:47], v[28:29], v[58:59], v[44:47] cbsz:1 abid:0
    v_mfma_f32_4x4x4_16b_bf16 v[48:51], v[28:29], v[60:61], v[48:51] cbsz:1 abid:0
    v_mfma_f32_4x4x4_16b_bf16 v[52:55], v[28:29], v[62:63], v[52:55] cbsz:1 abid:0
    v_mfma_f32_4x4x4_16b_bf16 v[40:43], v[28:29], v[72:73], v[40:43] cbsz:1 abid:1
    v_mfma_f32_4x4x4_16b_bf16 v[44:47], v[28:29], v[74:75], v[44:47] cbsz:1 abid:1
    v_mfma_f32_4x4x4_16b_bf16 v[48:51], v[28:29], v[76:77], v[48:51] cbsz:1 abid:1
    v_mfma_f32_4x4x4_16b_bf16 v[52:55], v[28:29], v[78:79], v[52:55] cbsz:1 abid:1
    v_mfma_f32_4x4x4_16b_bf16 v[40:43], v[30:31], v[64:65], v[40:43] cbsz:1 abid:0
    v_mfma_f32_4x4x4_16b_bf16 v[44:47], v[30:31], v[66:67], v[44:47] cbsz:1 abid:0
    v_mfma_f32_4x4x4_16b_bf16 v[48:51], v[30:31], v[68:69], v[48:51] cbsz:1 abid:0
    v_mfma_f32_4x4x4_16b_bf16 v[52:55], v[30:31], v[70:71], v[52:55] cbsz:1 abid:0
    v_mfma_f32_4x4x4_16b_bf16 v[40:43], v[30:31], v[80:81], v[40:43] cbsz:1 abid:1
    v_mfma_f32_4x4x4_16b_bf16 v[44:47], v[30:31], v[82:83], v[44:47] cbsz:1 abid:1
    v_mfma_f32_4x4x4_16b_bf16 v[48:51], v[30:31], v[84:85], v[48:51] cbsz:1 abid:1
    v_mfma_f32_4x4x4_16b_bf16 v[52:55], v[30:31], v[86:87], v[52:55] cbsz:1 abid:1
    s_branch L_main_done
L_part_A:
    s_waitcnt vmcnt(0) lgkmcnt(0)
    s_cmp_eq_u32 s69, 2
    s_cbranch_scc1 L_part2_A
    s_cmp_eq_u32 s69, 3
    s_cbranch_scc1 L_part3_A
    v_dot2_f32_bf16 v20, v88, v32, 0
    s_nop 2
    v_dot2c_f32_bf16 v20, v89, v33
    v_dot2c_f32_bf16 v20, v90, v34
    v_dot2c_f32_bf16 v20, v91, v35
    v_dot2c_f32_bf16 v20, v92, v36
    v_dot2c_f32_bf16 v20, v93, v37
    v_dot2c_f32_bf16 v20, v94, v38
    v_dot2c_f32_bf16 v20, v95, v39
    s_nop 2
    v_add_f32_dpp v24, v20, v20 row_half_mirror row_mask:0xf bank_mask:0x5
    s_nop 1
    v_add_f32_dpp v26, v24, v24 quad_perm:[1,0,3,2] row_mask:0xf bank_mask:0xf
    s_nop 1

    v_add_f32_dpp v27, v26, v26 quad_perm:[2,3,0,1] row_mask:0xf bank_mask:0xf
    v_mul_f32 v27, s51, v27
    v_exp_f32 v27, v27
    s_nop 0
    v_add_f32 v27, 1.0, v27
    v_rcp_f32 v27, v27
    s_nop 0
    v_cvt_pk_bf16_f32 v26, v27, v27
    s_nop 1
    v_and_b32_dpp v28, v26, v5 quad_perm:[0,0,0,0] row_mask:0xf bank_mask:0xf
    v_and_b32_dpp v29, v26, v6 quad_perm:[0,0,0,0] row_mask:0xf bank_mask:0xf

    s_nop 1
    v_mfma_f32_4x4x4_16b_bf16 v[40:43], v[28:29], v[88:89], v[40:43] cbsz:1 abid:0
    v_mfma_f32_4x4x4_16b_bf16 v[44:47], v[28:29], v[90:91], v[44:47] cbsz:1 abid:0
    v_mfma_f32_4x4x4_16b_bf16 v[48:51], v[28:29], v[92:93], v[48:51] cbsz:1 abid:0
    v_mfma_f32_4x4x4_16b_bf16 v[52:55], v[28:29], v[94:95], v[52:55] cbsz:1 abid:0
    s_branch L_main_done
L_part2_A:
    v_dot2_f32_bf16 v20, v88, v32, 0
    v_dot2_f32_bf16 v21, v96, v32, 0
    s_nop 1
    v_dot2c_f32_bf16 v20, v89, v33
    v_dot2c_f32_bf16 v21, v97, v33
    v_dot2c_f32_bf16 v20, v90, v34
    v_dot2c_f32_bf16 v21, v98, v34
    v_dot2c_f32_bf16 v20, v91, v35
    v_dot2c_f32_bf16 v21, v99, v35
    v_dot2c_f32_bf16 v20, v92, v36
    v_dot2c_f32_bf16 v21, v100, v36
    v_dot2c_f32_bf16 v20, v93, v37
    v_dot2c_f32_bf16 v21, v101, v37
    v_dot2c_f32_bf16 v20, v94, v38
    v_dot2c_f32_bf16 v21, v102, v38
    v_dot2c_f32_bf16 v20, v95, v39
    v_dot2c_f32_bf16 v21, v103, v39
    s_nop 1
    v_add_f32_dpp v24, v20, v20 row_half_mirror row_mask:0xf bank_mask:0x5
    v_add_f32_dpp v25, v21, v21 row_half_mirror row_mask:0xf bank_mask:0x5
    s_nop 1
    v_add_f32_dpp v26, v24, v24 quad_perm:[1,0,3,2] row_mask:0xf bank_mask:0xf
    s_nop 0
    v_add_f32_dpp v27, v25, v25 quad_perm:[1,0,3,2] row_mask:0xf bank_mask:0xf
    v_cndmask_b32 v26, v26, v27, s[52:53]
    s_nop 1

    v_add_f32_dpp v27, v26, v26 quad_perm:[2,3,0,1] row_mask:0xf bank_mask:0xf
    v_mul_f32 v27, s51, v27
    v_exp_f32 v27, v27
    s_nop 0
    v_add_f32 v27, 1.0, v27
    v_rcp_f32 v27, v27
    s_nop 0
    v_cvt_pk_bf16_f32 v26, v27, v27
    s_nop 1
    v_and_b32_dpp v28, v26, v5 quad_perm:[0,0,0,0] row_mask:0xf bank_mask:0xf
    v_and_b32_dpp v29, v26, v6 quad_perm:[0,0,0,0] row_mask:0xf bank_mask:0xf

    v_and_b32_dpp v30, v26, v5 quad_perm:[1,1,1,1] row_mask:0xf bank_mask:0xf
    v_and_b32_dpp v31, v26, v6 quad_perm:[1,1,1,1] row_mask:0xf bank_mask:0xf

    v_mfma_f32_4x4x4_16b_bf16 v[40:43], v[28:29], v[88:89], v[40:43] cbsz:1 abid:0
    v_mfma_f32_4x4x4_16b_bf16 v[44:47], v[28:29], v[90:91], v[44:47] cbsz:1 abid:0
    v_mfma_f32_4x4x4_16b_bf16 v[48:51], v[28:29], v[92:93], v[48:51] cbsz:1 abid:0
    v_mfma_f32_4x4x4_16b_bf16 v[52:55], v[28:29], v[94:95], v[52:55] cbsz:1 abid:0
    v_mfma_f32_4x4x4_16b_bf16 v[40:43], v[30:31], v[96:97], v[40:43] cbsz:1 abid:0
    v_mfma_f32_4x4x4_16b_bf16 v[44:47], v[30:31], v[98:99], v[44:47] cbsz:1 abid:0
    v_mfma_f32_4x4x4_16b_bf16 v[48:51], v[30:31], v[100:101], v[48:51] cbsz:1 abid:0
    v_mfma_f32_4x4x4_16b_bf16 v[52:55], v[30:31], v[102:103], v[52:55] cbsz:1 abid:0
    s_branch L_main_done
L_part3_A:
    v_dot2_f32_bf16 v20, v88, v32, 0
    v_dot2_f32_bf16 v21, v96, v32, 0
    v_dot2_f32_bf16 v22, v104, v32, 0
    s_nop 0
    v_dot2c_f32_bf16 v20, v89, v33
    v_dot2c_f32_bf16 v21, v97, v33
    v_dot2c_f32_bf16 v22, v105, v33
    v_dot2c_f32_bf16 v20, v90, v34
    v_dot2c_f32_bf16 v21, v98, v34
    v_dot2c_f32_bf16 v22, v106, v34
    v_dot2c_f32_bf16 v20, v91, v35
    v_dot2c_f32_bf16 v21, v99, v35
    v_dot2c_f32_bf16 v22, v107, v35
    v_dot2c_f32_bf16 v20, v92, v36
    v_dot2c_f32_bf16 v21, v100, v36
    v_dot2c_f32_bf16 v22, v108, v36
    v_dot2c_f32_bf16 v20, v93, v37
    v_dot2c_f32_bf16 v21, v101, v37
    v_dot2c_f32_bf16 v22, v109, v37
    v_dot2c_f32_bf16 v20, v94, v38
    v_dot2c_f32_bf16 v21, v102, v38
    v_dot2c_f32_bf16 v22, v110, v38
    v_dot2c_f32_bf16 v20, v95, v39
    v_dot2c_f32_bf16 v22, v111, v39
    v_dot2c_f32_bf16 v21, v103, v39
    s_nop 0
    v_add_f32_dpp v24, v20, v20 row_half_mirror row_mask:0xf bank_mask:0x5
    v_add_f32_dpp v24, v22, v22 row_half_mirror row_mask:0xf bank_mask:0xa
    v_add_f32_dpp v25, v21, v21 row_half_mirror row_mask:0xf bank_mask:0x5
    s_nop 1
    v_add_f32_dpp v26, v24, v24 quad_perm:[1,0,3,2] row_mask:0xf bank_mask:0xf
    s_nop 0
    v_add_f32_dpp v27, v25, v25 quad_perm:[1,0,3,2] row_mask:0xf bank_mask:0xf
    v_cndmask_b32 v26, v26, v27, s[52:53]
    s_nop 1

    v_add_f32_dpp v27, v26, v26 quad_perm:[2,3,0,1] row_mask:0xf bank_mask:0xf
    v_mul_f32 v27, s51, v27
    v_exp_f32 v27, v27
    s_nop 0
    v_add_f32 v27, 1.0, v27
    v_rcp_f32 v27, v27
    s_nop 0
    v_cvt_pk_bf16_f32 v26, v27, v27
    s_nop 1
    v_and_b32_dpp v28, v26, v5 quad_perm:[0,0,0,0] row_mask:0xf bank_mask:0xf
    v_and_b32_dpp v29, v26, v6 quad_perm:[0,0,0,0] row_mask:0xf bank_mask:0xf

    v_and_b32_dpp v30, v26, v5 quad_perm:[1,1,1,1] row_mask:0xf bank_mask:0xf
    v_and_b32_dpp v31, v26, v6 quad_perm:[1,1,1,1] row_mask:0xf bank_mask:0xf

    v_mfma_f32_4x4x4_16b_bf16 v[40:43], v[28:29], v[88:89], v[40:43] cbsz:1 abid:0
    v_mfma_f32_4x4x4_16b_bf16 v[44:47], v[28:29], v[90:91], v[44:47] cbsz:1 abid:0
    v_mfma_f32_4x4x4_16b_bf16 v[48:51], v[28:29], v[92:93], v[48:51] cbsz:1 abid:0
    v_mfma_f32_4x4x4_16b_bf16 v[52:55], v[28:29], v[94:95], v[52:55] cbsz:1 abid:0
    v_mfma_f32_4x4x4_16b_bf16 v[40:43], v[28:29], v[104:105], v[40:43] cbsz:1 abid:1
    v_mfma_f32_4x4x4_16b_bf16 v[44:47], v[28:29], v[106:107], v[44:47] cbsz:1 abid:1
    v_mfma_f32_4x4x4_16b_bf16 v[48:51], v[28:29], v[108:109], v[48:51] cbsz:1 abid:1
    v_mfma_f32_4x4x4_16b_bf16 v[52:55], v[28:29], v[110:111], v[52:55] cbsz:1 abid:1
    v_mfma_f32_4x4x4_16b_bf16 v[40:43], v[30:31], v[96:97], v[40:43] cbsz:1 abid:0
    v_mfma_f32_4x4x4_16b_bf16 v[44:47], v[30:31], v[98:99], v[44:47] cbsz:1 abid:0
    v_mfma_f32_4x4x4_16b_bf16 v[48:51], v[30:31], v[100:101], v[48:51] cbsz:1 abid:0
    v_mfma_f32_4x4x4_16b_bf16 v[52:55], v[30:31], v[102:103], v[52:55] cbsz:1 abid:0
    s_branch L_main_done
L_w1B:
    s_waitcnt vmcnt(2)
    s_branch L_goB
L_w2B:
    s_waitcnt vmcnt(4)
    s_branch L_goB
L_w3B:
    s_waitcnt vmcnt(6)
    s_branch L_goB
L_last4_B:
    s_waitcnt vmcnt(0) lgkmcnt(0)
    v_dot2_f32_bf16 v20, v88, v32, 0
    v_dot2_f32_bf16 v21, v96, v32, 0
    v_dot2_f32_bf16 v22, v104, v32, 0
    v_dot2_f32_bf16 v23, v112, v32, 0
    v_dot2c_f32_bf16 v20, v89, v33
    v_dot2c_f32_bf16 v21, v97, v33
    v_dot2c_f32_bf16 v22, v105, v33
    v_dot2c_f32_bf16 v23, v113, v33
    v_dot2c_f32_bf16 v20, v90, v34
    v_dot2c_f32_bf16 v21, v98, v34
    v_dot2c_f32_bf16 v22, v106, v34
    v_dot2c_f32_bf16 v23, v114, v34
    v_dot2c_f32_bf16 v20, v91, v35
    v_dot2c_f32_bf16 v21, v99, v35
    v_dot2c_f32_bf16 v22, v107, v35
    v_dot2c_f32_bf16 v23, v115, v35
    v_dot2c_f32_bf16 v20, v92, v36
    v_dot2c_f32_bf16 v21, v100, v36
    v_dot2c_f32_bf16 v22, v108, v36
    v_dot2c_f32_bf16 v23, v116, v36
    v_dot2c_f32_bf16 v20, v93, v37
    v_dot2c_f32_bf16 v21, v101, v37
    v_dot2c_f32_bf16 v22, v109, v37
    v_dot2c_f32_bf16 v23, v117, v37
    v_dot2c_f32_bf16 v20, v94, v38
    v_dot2c_f32_bf16 v21, v102, v38
    v_dot2c_f32_bf16 v22, v110, v38
    v_dot2c_f32_bf16 v23, v118, v38
    v_dot2c_f32_bf16 v20, v95, v39
    v_dot2c_f32_bf16 v22, v111, v39
    v_dot2c_f32_bf16 v21, v103, v39
    v_dot2c_f32_bf16 v23, v119, v39
    v_add_f32_dpp v24, v20, v20 row_half_mirror row_mask:0xf bank_mask:0x5
    v_add_f32_dpp v24, v22, v22 row_half_mirror row_mask:0xf bank_mask:0xa
    v_add_f32_dpp v25, v21, v21 row_half_mirror row_mask:0xf bank_mask:0x5
    v_add_f32_dpp v25, v23, v23 row_half_mirror row_mask:0xf bank_mask:0xa
    v_add_f32_dpp v26, v24, v24 quad_perm:[1,0,3,2] row_mask:0xf bank_mask:0xf
    s_nop 0
    v_add_f32_dpp v27, v25, v25 quad_perm:[1,0,3,2] row_mask:0xf bank_mask:0xf
    v_cndmask_b32 v26, v26, v27, s[52:53]
    s_nop 1

    v_add_f32_dpp v27, v26, v26 quad_perm:[2,3,0,1] row_mask:0xf bank_mask:0xf
    v_mul_f32 v27, s51, v27
    v_exp_f32 v27, v27
    s_nop 0
    v_add_f32 v27, 1.0, v27
    v_rcp_f32 v27, v27
    s_nop 0
    v_cvt_pk_bf16_f32 v26, v27, v27
    s_nop 1
    v_and_b32_dpp v28, v26, v5 quad_perm:[0,0,0,0] row_mask:0xf bank_mask:0xf
    v_and_b32_dpp v29, v26, v6 quad_perm:[0,0,0,0] row_mask:0xf bank_mask:0xf

    v_and_b32_dpp v30, v26, v5 quad_perm:[1,1,1,1] row_mask:0xf bank_mask:0xf
    v_and_b32_dpp v31, v26, v6 quad_perm:[1,1,1,1] row_mask:0xf bank_mask:0xf

    v_mfma_f32_4x4x4_16b_bf16 v[40:43], v[28:29], v[88:89], v[40:43] cbsz:1 abid:0
    v_mfma_f32_4x4x4_16b_bf16 v[44:47], v[28:29], v[90:91], v[44:47] cbsz:1 abid:0
    v_mfma_f32_4x4x4_16b_bf16 v[48:51], v[28:29], v[92:93], v[48:51] cbsz:1 abid:0
    v_mfma_f32_4x4x4_16b_bf16 v[52:55], v[28:29], v[94:95], v[52:55] cbsz:1 abid:0
    v_mfma_f32_4x4x4_16b_bf16 v[40:43], v[28:29], v[104:105], v[40:43] cbsz:1 abid:1
    v_mfma_f32_4x4x4_16b_bf16 v[44:47], v[28:29], v[106:107], v[44:47] cbsz:1 abid:1
    v_mfma_f32_4x4x4_16b_bf16 v[48:51], v[28:29], v[108:109], v[48:51] cbsz:1 abid:1
    v_mfma_f32_4x4x4_16b_bf16 v[52:55], v[28:29], v[110:111], v[52:55] cbsz:1 abid:1
    v_mfma_f32_4x4x4_16b_bf16 v[40:43], v[30:31], v[96:97], v[40:43] cbsz:1 abid:0
    v_mfma_f32_4x4x4_16b_bf16 v[44:47], v[30:31], v[98:99], v[44:47] cbsz:1 abid:0
    v_mfma_f32_4x4x4_16b_bf16 v[48:51], v[30:31], v[100:101], v[48:51] cbsz:1 abid:0
    v_mfma_f32_4x4x4_16b_bf16 v[52:55], v[30:31], v[102:103], v[52:55] cbsz:1 abid:0
    v_mfma_f32_4x4x4_16b_bf16 v[40:43], v[30:31], v[112:113], v[40:43] cbsz:1 abid:1
    v_mfma_f32_4x4x4_16b_bf16 v[44:47], v[30:31], v[114:115], v[44:47] cbsz:1 abid:1
    v_mfma_f32_4x4x4_16b_bf16 v[48:51], v[30:31], v[116:117], v[48:51] cbsz:1 abid:1
    v_mfma_f32_4x4x4_16b_bf16 v[52:55], v[30:31], v[118:119], v[52:55] cbsz:1 abid:1
    s_branch L_main_done
L_part_B:
    s_waitcnt vmcnt(0) lgkmcnt(0)
    s_cmp_eq_u32 s69, 2
    s_cbranch_scc1 L_part2_B
    s_cmp_eq_u32 s69, 3
    s_cbranch_scc1 L_part3_B
    v_dot2_f32_bf16 v20, v56, v32, 0
    s_nop 2
    v_dot2c_f32_bf16 v20, v57, v33
    v_dot2c_f32_bf16 v20, v58, v34
    v_dot2c_f32_bf16 v20, v59, v35
    v_dot2c_f32_bf16 v20, v60, v36
    v_dot2c_f32_bf16 v20, v61, v37
    v_dot2c_f32_bf16 v20, v62, v38
    v_dot2c_f32_bf16 v20, v63, v39
    s_nop 2
    v_add_f32_dpp v24, v20, v20 row_half_mirror row_mask:0xf bank_mask:0x5
    s_nop 1
    v_add_f32_dpp v26, v24, v24 quad_perm:[1,0,3,2] row_mask:0xf bank_mask:0xf
    s_nop 1

    v_add_f32_dpp v27, v26, v26 quad_perm:[2,3,0,1] row_mask:0xf bank_mask:0xf
    v_mul_f32 v27, s51, v27
    v_exp_f32 v27, v27
    s_nop 0
    v_add_f32 v27, 1.0, v27
    v_rcp_f32 v27, v27
    s_nop 0
    v_cvt_pk_bf16_f32 v26, v27, v27
    s_nop 1
    v_and_b32_dpp v28, v26, v5 quad_perm:[0,0,0,0] row_mask:0xf bank_mask:0xf
    v_and_b32_dpp v29, v26, v6 quad_perm:[0,0,0,0] row_mask:0xf bank_mask:0xf

    s_nop 1
    v_mfma_f32_4x4x4_16b_bf16 v[40:43], v[28:29], v[56:57], v[40:43] cbsz:1 abid:0
    v_mfma_f32_4x4x4_16b_bf16 v[44:47], v[28:29], v[58:59], v[44:47] cbsz:1 abid:0
    v_mfma_f32_4x4x4_16b_bf16 v[48:51], v[28:29], v[60:61], v[48:51] cbsz:1 abid:0
    v_mfma_f32_4x4x4_16b_bf16 v[52:55], v[28:29], v[62:63], v[52:55] cbsz:1 abid:0
    s_branch L_main_done
L_part2_B:
    v_dot2_f32_bf16 v20, v56, v32, 0
    v_dot2_f32_bf16 v21, v64, v32, 0
    s_nop 1
    v_dot2c_f32_bf16 v20, v57, v33
    v_dot2c_f32_bf16 v21, v65, v33
    v_dot2c_f32_bf16 v20, v58, v34
    v_dot2c_f32_bf16 v21, v66, v34
    v_dot2c_f32_bf16 v20, v59, v35
    v_dot2c_f32_bf16 v21, v67, v35
    v_dot2c_f32_bf16 v20, v60, v36
    v_dot2c_f32_bf16 v21, v68, v36
    v_dot2c_f32_bf16 v20, v61, v37
    v_dot2c_f32_bf16 v21, v69, v37
    v_dot2c_f32_bf16 v20, v62, v38
    v_dot2c_f32_bf16 v21, v70, v38
    v_dot2c_f32_bf16 v20, v63, v39
    v_dot2c_f32_bf16 v21, v71, v39
    s_nop 1
    v_add_f32_dpp v24, v20, v20 row_half_mirror row_mask:0xf bank_mask:0x5
    v_add_f32_dpp v25, v21, v21 row_half_mirror row_mask:0xf bank_mask:0x5
    s_nop 1
    v_add_f32_dpp v26, v24, v24 quad_perm:[1,0,3,2] row_mask:0xf bank_mask:0xf
    s_nop 0
    v_add_f32_dpp v27, v25, v25 quad_perm:[1,0,3,2] row_mask:0xf bank_mask:0xf
    v_cndmask_b32 v26, v26, v27, s[52:53]
    s_nop 1

    v_add_f32_dpp v27, v26, v26 quad_perm:[2,3,0,1] row_mask:0xf bank_mask:0xf
    v_mul_f32 v27, s51, v27
    v_exp_f32 v27, v27
    s_nop 0
    v_add_f32 v27, 1.0, v27
    v_rcp_f32 v27, v27
    s_nop 0
    v_cvt_pk_bf16_f32 v26, v27, v27
    s_nop 1
    v_and_b32_dpp v28, v26, v5 quad_perm:[0,0,0,0] row_mask:0xf bank_mask:0xf
    v_and_b32_dpp v29, v26, v6 quad_perm:[0,0,0,0] row_mask:0xf bank_mask:0xf

    v_and_b32_dpp v30, v26, v5 quad_perm:[1,1,1,1] row_mask:0xf bank_mask:0xf
    v_and_b32_dpp v31, v26, v6 quad_perm:[1,1,1,1] row_mask:0xf bank_mask:0xf

    v_mfma_f32_4x4x4_16b_bf16 v[40:43], v[28:29], v[56:57], v[40:43] cbsz:1 abid:0
    v_mfma_f32_4x4x4_16b_bf16 v[44:47], v[28:29], v[58:59], v[44:47] cbsz:1 abid:0
    v_mfma_f32_4x4x4_16b_bf16 v[48:51], v[28:29], v[60:61], v[48:51] cbsz:1 abid:0
    v_mfma_f32_4x4x4_16b_bf16 v[52:55], v[28:29], v[62:63], v[52:55] cbsz:1 abid:0
    v_mfma_f32_4x4x4_16b_bf16 v[40:43], v[30:31], v[64:65], v[40:43] cbsz:1 abid:0
    v_mfma_f32_4x4x4_16b_bf16 v[44:47], v[30:31], v[66:67], v[44:47] cbsz:1 abid:0
    v_mfma_f32_4x4x4_16b_bf16 v[48:51], v[30:31], v[68:69], v[48:51] cbsz:1 abid:0
    v_mfma_f32_4x4x4_16b_bf16 v[52:55], v[30:31], v[70:71], v[52:55] cbsz:1 abid:0
    s_branch L_main_done
L_part3_B:
    v_dot2_f32_bf16 v20, v56, v32, 0
    v_dot2_f32_bf16 v21, v64, v32, 0
    v_dot2_f32_bf16 v22, v72, v32, 0
    s_nop 0
    v_dot2c_f32_bf16 v20, v57, v33
    v_dot2c_f32_bf16 v21, v65, v33
    v_dot2c_f32_bf16 v22, v73, v33
    v_dot2c_f32_bf16 v20, v58, v34
    v_dot2c_f32_bf16 v21, v66, v34
    v_dot2c_f32_bf16 v22, v74, v34
    v_dot2c_f32_bf16 v20, v59, v35
    v_dot2c_f32_bf16 v21, v67, v35
    v_dot2c_f32_bf16 v22, v75, v35
    v_dot2c_f32_bf16 v20, v60, v36
    v_dot2c_f32_bf16 v21, v68, v36
    v_dot2c_f32_bf16 v22, v76, v36
    v_dot2c_f32_bf16 v20, v61, v37
    v_dot2c_f32_bf16 v21, v69, v37
    v_dot2c_f32_bf16 v22, v77, v37
    v_dot2c_f32_bf16 v20, v62, v38
    v_dot2c_f32_bf16 v21, v70, v38
    v_dot2c_f32_bf16 v22, v78, v38
    v_dot2c_f32_bf16 v20, v63, v39
    v_dot2c_f32_bf16 v22, v79, v39
    v_dot2c_f32_bf16 v21, v71, v39
    s_nop 0
    v_add_f32_dpp v24, v20, v20 row_half_mirror row_mask:0xf bank_mask:0x5
    v_add_f32_dpp v24, v22, v22 row_half_mirror row_mask:0xf bank_mask:0xa
    v_add_f32_dpp v25, v21, v21 row_half_mirror row_mask:0xf bank_mask:0x5
    s_nop 1
    v_add_f32_dpp v26, v24, v24 quad_perm:[1,0,3,2] row_mask:0xf bank_mask:0xf
    s_nop 0
    v_add_f32_dpp v27, v25, v25 quad_perm:[1,0,3,2] row_mask:0xf bank_mask:0xf
    v_cndmask_b32 v26, v26, v27, s[52:53]
    s_nop 1

    v_add_f32_dpp v27, v26, v26 quad_perm:[2,3,0,1] row_mask:0xf bank_mask:0xf
    v_mul_f32 v27, s51, v27
    v_exp_f32 v27, v27
    s_nop 0
    v_add_f32 v27, 1.0, v27
    v_rcp_f32 v27, v27
    s_nop 0
    v_cvt_pk_bf16_f32 v26, v27, v27
    s_nop 1
    v_and_b32_dpp v28, v26, v5 quad_perm:[0,0,0,0] row_mask:0xf bank_mask:0xf
    v_and_b32_dpp v29, v26, v6 quad_perm:[0,0,0,0] row_mask:0xf bank_mask:0xf

    v_and_b32_dpp v30, v26, v5 quad_perm:[1,1,1,1] row_mask:0xf bank_mask:0xf
    v_and_b32_dpp v31, v26, v6 quad_perm:[1,1,1,1] row_mask:0xf bank_mask:0xf

    v_mfma_f32_4x4x4_16b_bf16 v[40:43], v[28:29], v[56:57], v[40:43] cbsz:1 abid:0
    v_mfma_f32_4x4x4_16b_bf16 v[44:47], v[28:29], v[58:59], v[44:47] cbsz:1 abid:0
    v_mfma_f32_4x4x4_16b_bf16 v[48:51], v[28:29], v[60:61], v[48:51] cbsz:1 abid:0
    v_mfma_f32_4x4x4_16b_bf16 v[52:55], v[28:29], v[62:63], v[52:55] cbsz:1 abid:0
    v_mfma_f32_4x4x4_16b_bf16 v[40:43], v[28:29], v[72:73], v[40:43] cbsz:1 abid:1
    v_mfma_f32_4x4x4_16b_bf16 v[44:47], v[28:29], v[74:75], v[44:47] cbsz:1 abid:1
    v_mfma_f32_4x4x4_16b_bf16 v[48:51], v[28:29], v[76:77], v[48:51] cbsz:1 abid:1
    v_mfma_f32_4x4x4_16b_bf16 v[52:55], v[28:29], v[78:79], v[52:55] cbsz:1 abid:1
    v_mfma_f32_4x4x4_16b_bf16 v[40:43], v[30:31], v[64:65], v[40:43] cbsz:1 abid:0
    v_mfma_f32_4x4x4_16b_bf16 v[44:47], v[30:31], v[66:67], v[44:47] cbsz:1 abid:0
    v_mfma_f32_4x4x4_16b_bf16 v[48:51], v[30:31], v[68:69], v[48:51] cbsz:1 abid:0
    v_mfma_f32_4x4x4_16b_bf16 v[52:55], v[30:31], v[70:71], v[52:55] cbsz:1 abid:0
    L_main_done:
    s_cmp_lg_u32 s56, 0
    s_cbranch_scc1 L_slow_next
    L_epi:

    s_setprio 3
    s_cmp_ge_u32 s48, 12
    s_cbranch_scc1 L_nofrag

    ds_read_b64_tr_b16 v[56:57], v120 offset:32768
    ds_read_b64_tr_b16 v[58:59], v120 offset:33792
    ds_read_b64_tr_b16 v[72:73], v127 offset:32768
    ds_read_b64_tr_b16 v[74:75], v127 offset:33792
    ds_read_b64_tr_b16 v[60:61], v120 offset:40960
    ds_read_b64_tr_b16 v[62:63], v120 offset:41984
    ds_read_b64_tr_b16 v[76:77], v127 offset:40960
    ds_read_b64_tr_b16 v[78:79], v127 offset:41984
    ds_read_b64_tr_b16 v[64:65], v120 offset:49152
    ds_read_b64_tr_b16 v[66:67], v120 offset:50176
    ds_read_b64_tr_b16 v[80:81], v127 offset:49152
    ds_read_b64_tr_b16 v[82:83], v127 offset:50176
    ds_read_b64_tr_b16 v[68:69], v120 offset:57344
    ds_read_b64_tr_b16 v[70:71], v120 offset:58368
    ds_read_b64_tr_b16 v[84:85], v127 offset:57344
    ds_read_b64_tr_b16 v[86:87], v127 offset:58368
L_nofrag:
    s_nop 3
    v_permlane32_swap_b32 v40, v48
    v_permlane32_swap_b32 v41, v49
    v_permlane32_swap_b32 v42, v50
    v_permlane32_swap_b32 v43, v51
    v_permlane32_swap_b32 v44, v52
    v_permlane32_swap_b32 v45, v53
    v_permlane32_swap_b32 v46, v54
    v_permlane32_swap_b32 v47, v55
    v_add_f32 v40, v40, v48
    v_add_f32 v41, v41, v49
    v_add_f32 v42, v42, v50
    v_add_f32 v43, v43, v51
    v_add_f32 v44, v44, v52
    v_add_f32 v45, v45, v53
    v_add_f32 v46, v46, v54
    v_add_f32 v47, v47, v55
    s_cmp_eq_u32 s76, 1
    s_cbranch_scc1 L_red2

    v_cvt_pk_bf16_f32 v48, v40, v41
    v_cvt_pk_bf16_f32 v49, v42, v43
    v_cvt_pk_bf16_f32 v50, v44, v45
    v_cvt_pk_bf16_f32 v51, v46, v47
    ds_write_b128 v126, v[48:51] offset:17152
    s_branch L_part_done
    L_red2:
    s_nop 0

    v_permlane16_swap_b32 v40, v44
    v_permlane16_swap_b32 v41, v45
    v_permlane16_swap_b32 v42, v46
    v_permlane16_swap_b32 v43, v47
    v_add_f32 v40, v40, v44
    v_add_f32 v41, v41, v45
    v_add_f32 v42, v42, v46
    v_add_f32 v43, v43, v47
    v_cvt_pk_bf16_f32 v48, v40, v41
    v_cvt_pk_bf16_f32 v49, v42, v43
    ds_write_b64 v126, v[48:49] offset:17152
    L_part_done:

    s_lshl_b32 s64, s48, 6
    s_and_b32 s64, s64, 0xc0
    v_subrev_u32 v3, s64, v122
    s_waitcnt lgkmcnt(0)
    s_barrier

    s_cmp_ge_u32 s48, 12
    s_cbranch_scc1 L_fin

    ds_read_b128 v[88:91], v3 offset:17152
    ds_read_b128 v[92:95], v3 offset:17216
    ds_read_b128 v[96:99], v3 offset:17280
    ds_read_b128 v[100:103], v3 offset:17344
    s_waitcnt lgkmcnt(3)
    v_mfma_f32_16x16x32_bf16 v[28:31], v[56:59], v[88:91], 0
    v_mfma_f32_16x16x32_bf16 v[32:35], v[72:75], v[88:91], 0
    s_waitcnt lgkmcnt(2)
    v_mfma_f32_16x16x32_bf16 v[28:31], v[60:63], v[92:95], v[28:31]
    v_mfma_f32_16x16x32_bf16 v[32:35], v[76:79], v[92:95], v[32:35]
    s_waitcnt lgkmcnt(1)
    v_mfma_f32_16x16x32_bf16 v[28:31], v[64:67], v[96:99], v[28:31]
    v_mfma_f32_16x16x32_bf16 v[32:35], v[80:83], v[96:99], v[32:35]
    s_waitcnt lgkmcnt(0)
    v_mfma_f32_16x16x32_bf16 v[28:31], v[68:71], v[100:103], v[28:31]
    v_mfma_f32_16x16x32_bf16 v[32:35], v[84:87], v[100:103], v[32:35]
    s_nop 7
    s_nop 1

    v_cvt_pk_bf16_f32 v36, v28, v29
    v_cvt_pk_bf16_f32 v38, v32, v33
    v_cvt_pk_bf16_f32 v37, v30, v31
    v_cvt_pk_bf16_f32 v39, v34, v35
    s_nop 0
    v_permlane32_swap_b32 v36, v38
    v_permlane32_swap_b32 v37, v39
    s_nop 0
    v_permlane16_swap_b32 v36, v38
    v_permlane16_swap_b32 v37, v39

    s_mov_b64 exec, s[78:79]
    s_cbranch_execz L_fin
    buffer_store_dwordx4 v[36:39], v123, s[40:43], 0 offen sc1
    s_lshl_b32 s64, s2, 4
    s_or_b32 s64, s64, s48
    s_cmp_eq_u32 s64, 0
    s_cbranch_scc1 L_bump
    L_fin:
    s_mov_b64 exec, -1

    s_endpgm
    L_bump:
    s_mov_b64 exec, 1
    v_mov_b32 v8, 0
    v_mov_b32 v9, 1
    buffer_atomic_add v9, v8, s[44:47], 0 offen
    s_branch L_fin

    L_storeB:
    s_mov_b64 exec, s[68:69]

    ds_read_b32 v20, v117 offset:17024
    ds_read_b32 v21, v117 offset:19200
    ds_read_b32 v22, v117 offset:21376
    ds_read_b32 v23, v117 offset:23552
    ds_read_b32 v24, v117 offset:25728
    v_and_b32 v8, 3, v0
    v_sub_u32 v27, v26, v8
    v_mov_b32 v28, 0x1fffff
    v_cmp_lt_u32 vcc, 40, v26
    s_nop 1
    v_cndmask_b32 v16, 0, 1, vcc
    v_lshl_or_b32 v16, v16, 22, v31
    s_waitcnt lgkmcnt(0)

    v_cmp_lt_u32 vcc, 20, v27
    s_nop 1
    v_cndmask_b32 v20, v28, v20, vcc
    v_cmp_lt_u32 vcc, 24, v27
    s_nop 1
    v_cndmask_b32 v21, v28, v21, vcc
    v_cmp_lt_u32 vcc, 28, v27
    s_nop 1
    v_cndmask_b32 v22, v28, v22, vcc
    v_cmp_lt_u32 vcc, 32, v27
    s_nop 1
    v_cndmask_b32 v23, v28, v23, vcc
    v_cmp_lt_u32 vcc, 36, v27
    s_nop 1
    v_cndmask_b32 v24, v28, v24, vcc
    v_lshl_or_b32 v16, v20, 23, v16
    v_lshrrev_b32 v17, 9, v20
    v_lshrrev_b32 v18, 20, v21
    v_lshrrev_b32 v19, 10, v23
    v_lshl_or_b32 v17, v21, 12, v17
    v_lshl_or_b32 v18, v22, 1, v18
    v_lshl_or_b32 v19, v24, 11, v19
    v_lshl_or_b32 v18, v23, 22, v18

    s_add_u32 s66, s66, 2048000
    buffer_store_dwordx4 v[16:19], v118, s[44:47], s66 offen sc1
    s_branch L_storeB_done
    L_issueB:
    s_add_u32 s67, s66, 2048000
    s_mov_b64 exec, s[10:11]
    buffer_load_dwordx4 v[56:59], v119, s[44:47], s67 offen sc1
    s_mov_b64 exec, s[60:61]
    s_branch L_issueB_done
    L_pollB_l:
    buffer_load_dwordx4 v[56:59], v119, s[44:47], s67 offen sc1
    L_pollB:
    s_mov_b64 exec, s[10:11]
    s_sub_u32 s55, s55, 1
    s_cbranch_scc1 L_timeoutB
    s_waitcnt vmcnt(0)
    v_and_b32 v16, 0x3fffff, v56
    v_cmp_ne_u32 vcc, v31, v16
    s_wqm_b64 exec, vcc
    s_cbranch_scc1 L_pollB_l
    s_mov_b64 exec, s[10:11]
    v_and_b32 v16, 0x400000, v56
    v_cmp_ne_u32 vcc, 0, v16
    s_cbranch_vccnz L_timeoutB
    s_waitcnt lgkmcnt(0)

    v_alignbit_b32 v20, v57, v56, 22
    v_alignbit_b32 v21, v58, v57, 11
    v_alignbit_b32 v23, v59, v58, 21
    v_lshrrev_b32 v24, 10, v59

    v_and_b32 v26, 0xfe, v20
    v_and_b32 v27, 0xfe, v21
    v_and_b32 v28, 0xfe, v58
    v_and_b32 v29, 0xfe, v23
    v_and_b32 v30, 0xfe, v24
    v_lshl_add_u32 v26, v26, 1, s64
    v_lshl_add_u32 v27, v27, 1, s64
    v_lshl_add_u32 v28, v28, 1, s64
    v_lshl_add_u32 v29, v29, 1, s64
    v_lshl_add_u32 v30, v30, 1, s64
    v_cmp_gt_u32 s[68:69], s65, v26
    v_cmp_gt_u32 s[70:71], s65, v27
    v_cmp_gt_u32 s[72:73], s65, v28
    v_cmp_gt_u32 s[74:75], s65, v29
    v_cmp_gt_u32 s[8:9], s65, v30
    s_mov_b64 exec, s[68:69]
    ds_add_rtn_u32 v32, v26, v3 offset:1024

    s_mov_b64 exec, s[70:71]
    ds_add_rtn_u32 v33, v27, v3 offset:1024

    s_mov_b64 exec, s[72:73]
    ds_add_rtn_u32 v34, v28, v3 offset:1024

    s_mov_b64 exec, s[74:75]
    ds_add_rtn_u32 v35, v29, v3 offset:1024

    s_mov_b64 exec, s[8:9]
    ds_add_rtn_u32 v36, v30, v3 offset:1024

    s_mov_b64 exec, s[68:69]
    s_waitcnt lgkmcnt(4)
    ds_write_b32 v32, v20

    s_mov_b64 exec, s[70:71]
    s_waitcnt lgkmcnt(4)
    ds_write_b32 v33, v21

    s_mov_b64 exec, s[72:73]
    s_waitcnt lgkmcnt(4)
    ds_write_b32 v34, v58

    s_mov_b64 exec, s[74:75]
    s_waitcnt lgkmcnt(4)
    ds_write_b32 v35, v23

    s_mov_b64 exec, s[8:9]
    s_waitcnt lgkmcnt(4)
    ds_write_b32 v36, v24

    s_branch L_poll_done
    L_slow:
    s_waitcnt vmcnt(0) lgkmcnt(0)
    s_cmp_lg_u32 s56, 0
    s_cbranch_scc1 L_slow_halve
    s_mov_b32 s56, 1
    s_mov_b32 s57, 0
    s_mov_b32 s58, 80000

    s_branch L_slow_round
    L_slow_halve:
    s_lshr_b32 s58, s58, 1
    s_max_u32 s58, s58, 16
    L_slow_round:
    s_waitcnt lgkmcnt(0)
    s_barrier
    v_lshlrev_b32 v8, 4, v0
    v_mov_b32 v12, -1
    v_mov_b32 v13, v12
    v_mov_b32 v14, v12
    v_mov_b32 v15, v12
    v_mov_b32 v78, 4
    v_cmp_gt_u32 vcc, 680, v0
    s_and_saveexec_b64 s[62:63], vcc
    v_add_u32 v9, 108032, v8
    ds_write_b128 v9, v[12:15]
    s_mov_b64 exec, s[62:63]
    s_cmp_lg_u32 s48, 15
    s_cbranch_scc1 L_slow_cleared
    v_lshlrev_b32 v9, 2, v1
    ds_write_b32 v9, v7 offset:1024
    L_slow_cleared:
    s_waitcnt lgkmcnt(0)
    s_barrier
    s_mul_i32 s66, s54, 40
    v_add_u32 v79, s57, v0
    s_add_u32 s67, s57, s58
    s_min_u32 s67, s67, 80000
    s_mov_b32 s64, s57
    s_mov_b32 s65, 108300
    v_mov_b32 v77, 68
    L_scan:
    v_cmp_gt_u32 vcc, s67, v79
    s_and_saveexec_b64 s[62:63], vcc
    s_cbranch_execz L_scan_next
    v_lshlrev_b32 v9, 4, v79
    buffer_load_dwordx4 v[56:59], v9, s[28:31], 0 offen
    buffer_load_dwordx4 v[60:63], v9, s[24:27], 0 offen
    s_mov_b64 s[60:61], exec
    s_waitcnt vmcnt(0)

    v_subrev_u32 v64, s66, v56
    v_cmp_gt_u32 s[4:5], 40, v64
    v_lshlrev_b32 v68, 2, v64
    v_subrev_u32 v65, s66, v57
    v_cmp_gt_u32 s[6:7], 40, v65
    v_lshlrev_b32 v69, 2, v65
    v_subrev_u32 v66, s66, v58
    v_cmp_gt_u32 s[8:9], 40, v66
    v_lshlrev_b32 v70, 2, v66
    v_subrev_u32 v67, s66, v59
    v_cmp_gt_u32 s[10:11], 40, v67
    v_lshlrev_b32 v71, 2, v67
    s_and_b64 exec, s[60:61], s[4:5]
    ds_add_rtn_u32 v72, v68, v78 offset:1024
    s_and_b64 exec, s[60:61], s[6:7]
    ds_add_rtn_u32 v73, v69, v78 offset:1024
    s_and_b64 exec, s[60:61], s[8:9]
    ds_add_rtn_u32 v74, v70, v78 offset:1024
    s_and_b64 exec, s[60:61], s[10:11]
    ds_add_rtn_u32 v75, v71, v78 offset:1024
    s_mov_b64 exec, s[60:61]
    s_waitcnt lgkmcnt(0)
    v_mad_u32_u24 v64, v68, v77, s65
    v_min_u32 v64, v64, v72
    v_lshlrev_b32 v60, 8, v60
    s_and_b64 exec, s[60:61], s[4:5]
    ds_write_b32 v64, v60
    s_mov_b64 exec, s[60:61]
    v_mad_u32_u24 v65, v69, v77, s65
    v_min_u32 v65, v65, v73
    v_lshlrev_b32 v61, 8, v61
    s_and_b64 exec, s[60:61], s[6:7]
    ds_write_b32 v65, v61
    s_mov_b64 exec, s[60:61]
    v_mad_u32_u24 v66, v70, v77, s65
    v_min_u32 v66, v66, v74
    v_lshlrev_b32 v62, 8, v62
    s_and_b64 exec, s[60:61], s[8:9]
    ds_write_b32 v66, v62
    s_mov_b64 exec, s[60:61]
    v_mad_u32_u24 v67, v71, v77, s65
    v_min_u32 v67, v67, v75
    v_lshlrev_b32 v63, 8, v63
    s_and_b64 exec, s[60:61], s[10:11]
    ds_write_b32 v67, v63
    s_mov_b64 exec, s[60:61]
    L_scan_next:
    s_mov_b64 exec, s[62:63]
    v_add_u32 v79, 1024, v79
    s_add_u32 s64, s64, 1024
    s_cmp_lt_u32 s64, s67
    s_cbranch_scc1 L_scan
    s_waitcnt lgkmcnt(0)
    s_barrier
    s_branch L_main_setup
    L_slow_next:
    s_add_u32 s57, s57, s58
    s_cmp_lt_u32 s57, 80000
    s_cbranch_scc1 L_slow_round
    s_branch L_epi
    L_end:
    s_endpgm

.section .rodata,"a"
.p2align 6
.amdhsa_kernel gather_scatter__kernel_systems_refs_featgraph__graph_kernel
  .amdhsa_next_free_vgpr 128
  .amdhsa_next_free_sgpr 80
  .amdhsa_accum_offset 128
  .amdhsa_group_segment_fixed_size 0
  .amdhsa_kernarg_size 64
  .amdhsa_user_sgpr_count 2
  .amdhsa_user_sgpr_kernarg_segment_ptr 1
  .amdhsa_system_sgpr_workgroup_id_x 1
.end_amdhsa_kernel
```
